```python
import torch

def _softmax(x, axis=-1):
    return torch.softmax(x, dim=axis)

def _gelu(x):
    return torch.nn.functional.gelu(x, approximate='tanh')

def _silu(x):
    return torch.nn.functional.silu(x)

def _sigmoid(x):
    return torch.sigmoid(x)

def _layernorm(x, axis=-1, eps=1e-05):
    m = x.mean(dim=axis, keepdim=True)
    v = x.var(dim=axis, keepdim=True, unbiased=False)
    return (x - m) / torch.sqrt(v + eps)

def _scatter_add(tgt, idx, src, axis=0):
    return tgt.clone().index_add_(axis, idx, src)

def _segment_sum(src, seg, n):
    out = torch.zeros((n,) + src.shape[1:], dtype=src.dtype)
    return out.index_add_(0, seg, src)

def _pad(x, pw):
    flat = tuple((v for pair in reversed(pw) for v in pair))
    return torch.nn.functional.pad(x, flat)
kernel_name = 'gated_mix__ssm_conv_h3__mixer_gmlp__prompt'

def setup_inputs():

    _w = lambda a: (lambda t: t.to(torch.bfloat16) if t.is_floating_point() else t)(torch.as_tensor(a))

    def _A_setup():
        B, S, D = (1, 2048, 448)
        ks = 4
        return {'q': _w((lambda *s: torch.randn(*s, dtype=torch.bfloat16) * 0.05)(B, S, D)), 'k': _w((lambda *s: torch.randn(*s, dtype=torch.bfloat16) * 1.6)(B, S, D)), 'v': _w((lambda *s: torch.randn(*s, dtype=torch.bfloat16) * 1.6)(B, S, D)), 'shift_k': _w((lambda *s: torch.randn(*s, dtype=torch.bfloat16) * 1.6)(D, ks) * 0.5), 'ssm_k': _w((lambda *s: torch.randn(*s, dtype=torch.bfloat16) * 3.2)(D, S) * (1.0 / S ** 0.5)), 'ssm_D': _w((lambda *s: torch.randn(*s, dtype=torch.bfloat16) * 1.6)(D))}
    _A_in = _A_setup()

    def _B_setup():
        B, S, D, F = (1, 2048, 448, 1792)
        Fh = F // 2
        return {'x': _w((lambda *s: torch.randn(*s, dtype=torch.bfloat16) * 0.05)(B, S, D)), 'w_in': _w((lambda *s: torch.randn(*s, dtype=torch.bfloat16) * 0.8)(D, 2 * Fh)), 'w_sp': _w(0.01 * (lambda *s: torch.randn(*s, dtype=torch.bfloat16) * 0.8)(S, S)), 'b_sp': _w(1.0 + 0.01 * (lambda *s: torch.randn(*s, dtype=torch.bfloat16) * 0.1)(S)), 'w_out': _w((lambda *s: torch.randn(*s, dtype=torch.bfloat16) * 0.1)(Fh, D))}
    _B_in = _B_setup()
    return {'A_q': _A_in['q'], 'A_k': _A_in['k'], 'A_v': _A_in['v'], 'A_shift_k': _A_in['shift_k'], 'A_ssm_k': _A_in['ssm_k'], 'A_ssm_D': _A_in['ssm_D'], 'B_x': _B_in['x'], 'B_w_in': _B_in['w_in'], 'B_w_sp': _B_in['w_sp'], 'B_b_sp': _B_in['b_sp'], 'B_w_out': _B_in['w_out'], 'gate_w': _w((lambda *s: torch.randn(*s, dtype=torch.bfloat16) * 0.05)(448) * 16.0)}

def reference(A_q, A_k, A_v, A_shift_k, A_ssm_k, A_ssm_D, B_x, B_w_in, B_w_sp, B_b_sp, B_w_out, gate_w):

    def _A_ref(q, k, v, shift_k, ssm_k, ssm_D):
        B, S, D = q.shape
        ks = shift_k.shape[-1]
        k_pad = _pad(k, ((0, 0), (ks - 1, 0), (0, 0)))
        k_shift = torch.zeros_like(k)
        for t in range(ks):
            k_shift = k_shift + k_pad[:, t:t + S, :] * shift_k[:, ks - 1 - t][None, None, :]
        kv = k_shift * v
        L = 2 * S
        kv_pad = _pad(kv, ((0, 0), (0, S), (0, 0)))
        kf_pad = _pad(ssm_k, ((0, 0), (0, S)))
        kv_f = (lambda x, axes=(-2, -1): torch.fft.rfft2(x.float(), dim=axes))(kv_pad[:, None, :, :], axes=(1, 2))
        kf_f = (lambda x, axes=(-2, -1): torch.fft.rfft2(x.float(), dim=axes))(kf_pad[:, None, :], axes=(1, 2))
        kf_f = (lambda x, *d: x.permute(*d))(kf_f, 1, 2, 0)
        y_f = kv_f * kf_f[None, :, :, :]
        y = (lambda x, s, axes=(-2, -1): torch.fft.irfft2(x, s=s, dim=axes).to(torch.bfloat16))(y_f, (1, L), axes=(1, 2))[:, 0, :S, :]
        y = y + kv * ssm_D[None, None, :]
        return q * y

    def _B_ref(x, w_in, w_sp, b_sp, w_out):
        B, S, D = x.shape
        F = w_in.shape[-1]
        Fh = F // 2
        z = _gelu(torch.einsum('bsd,df->bsf', x, w_in))
        z1 = z[..., :Fh].clone()
        z2 = _layernorm(z[..., Fh:], axis=-1)
        g = torch.einsum('ts,bsf->btf', w_sp, z2) + b_sp[None, :, None]
        return torch.einsum('bsf,fd->bsd', z1 * g, w_out)
    x = A_q
    g = _sigmoid((x * gate_w).sum(-1, keepdims=True))
    a = _A_ref(x, A_k, A_v, A_shift_k, A_ssm_k, A_ssm_D)
    b = _B_ref(x, B_w_in, B_w_sp, B_b_sp, B_w_out)
    return g * a + (1 - g) * b
```

```asm
; @launch grid=(256,1,1) block=(256,1,1) lds=163840
.amdgcn_target "amdgcn-amd-amdhsa--gfx950"
.text
.globl gated_mix__ssm_conv_h3__mixer_gmlp__prompt_kernel
.p2align 8
.type gated_mix__ssm_conv_h3__mixer_gmlp__prompt_kernel,@function
gated_mix__ssm_conv_h3__mixer_gmlp__prompt_kernel:
    s_load_dwordx2 s[4:5], s[0:1], 0
    s_load_dwordx2 s[8:9], s[0:1], 56
    s_load_dwordx2 s[12:13], s[0:1], 112
    s_load_dwordx2 s[16:17], s[0:1], 64
    s_lshr_b32 s45, s2, 3
    s_getpc_b64 s[50:51]
    s_and_b32 s46, s45, 15
    s_min_u32 s46, s46, 9
    s_lshl_b32 s46, s46, 12
    v_lshl_add_u32 v2, v0, 4, s46
    global_load_dwordx4 v[4:7], v2, s[50:51]
    v_lshrrev_b32 v1, 6, v0
    v_and_b32 v0, 63, v0
    s_and_b32 s38, s2, 1
    v_readfirstlane_b32 s36, v1
    v_lshrrev_b32 v63, 3, v0
    s_cmp_lt_u32 s2, 224
    s_cbranch_scc1 L_worker
    s_cmp_ge_u32 s2, 256
    s_cbranch_scc1 L_hend
    s_sub_u32 s84, s2, 224
    s_lshr_b32 s85, s84, 3
    s_lshl2_add_u32 s89, s84, s36
    s_and_b32 s45, s2, 6
    s_lshl1_add_u32 s39, s45, s85
    s_lshl2_add_u32 s45, s39, s36
    s_lshl_b32 s45, s45, 6
    s_add_u32 s45, s45, s38
    s_lshl_b32 s90, s45, 11
    s_mul_i32 s46, s89, 14336
    v_and_b32 v2, 15, v0
    v_min_u32 v2, 13, v2
    v_lshrrev_b32 v3, 4, v0
    v_mul_u32_u24 v8, 28, v3
    v_add_lshl_u32 v8, v2, v8, 7
    v_lshrrev_b32 v2, 1, v0
    v_and_b32 v3, 1, v0
    v_lshl_add_u32 v18, v2, 4, v3
    v_lshlrev_b32 v18, 8, v18
    s_mov_b32 s10, 1605632
    s_mov_b32 s11, 0x20000
    s_mov_b32 s18, 8388608
    s_mov_b32 s19, 0x20000
    s_waitcnt lgkmcnt(0)
    buffer_load_dword v9, v8, s[8:11], s46 offen
    s_mov_b32 exec_lo, 0x55555555
    s_mov_b32 exec_hi, 0x55555555
    buffer_load_dword v9, v18, s[16:19], s90 offen offset:1792
    s_mov_b64 exec, -1
    buffer_load_dword v9, v18, s[16:19], s90 offen offset:128
    buffer_load_dword v9, v18, s[16:19], s90 offen offset:640
    s_branch L_notworker
L_worker:
    s_mul_i32 s44, s45, 37
    s_lshr_b32 s44, s44, 8
    s_mul_i32 s47, s44, 7
    s_sub_u32 s37, s45, s47
    s_and_b32 s45, s2, 6
    s_lshl1_add_u32 s39, s45, s44
    s_lshl1_add_u32 s40, s37, s38
    s_mul_i32 s53, s36, 24576
    s_add_u32 s53, s53, 57344
    s_lshl2_add_u32 s45, s39, s36
    s_mul_i32 s48, s45, 224
    s_lshl1_add_u32 s69, s44, s37
    s_add_u32 s69, s69, 2
    s_mul_i32 s45, s69, 37
    s_lshr_b32 s45, s45, 8
    s_mul_i32 s45, s45, 7
    s_sub_u32 s69, s69, s45
    s_add_u32 s45, s48, s69
    s_lshl_b32 s54, s45, 7
    v_and_b32 v1, 7, v0
    v_lshrrev_b32 v2, 4, v0
    v_xor_b32 v68, v1, v2
    v_lshlrev_b32 v68, 4, v68
    v_and_b32 v3, 4, v63
    v_add_u32 v69, v3, v63
    v_mul_u32_u24 v3, 896, v69
    v_add_u32 v64, v3, v68
    v_xor_b32 v65, 64, v64
    v_add_u32 v66, 1536, v64
    v_add_u32 v67, 14848, v65
    v_add_u32 v65, 13312, v65
    s_mov_b32 s6, 1835008
    s_mov_b32 s7, 0x20000
    s_mov_b32 m0, s53
    s_waitcnt lgkmcnt(0)
    buffer_load_dwordx4 v64, s[4:7], s54 offen  lds
    buffer_load_dwordx4 v65, s[4:7], s54 offen offset:1024  lds
    buffer_load_dwordx4 v66, s[4:7], s54 offen offset:2048  lds
    buffer_load_dwordx4 v67, s[4:7], s54 offen offset:3072  lds
    v_lshlrev_b32 v2, 1, v2
    v_xor_b32 v54, v1, v2
    v_lshlrev_b32 v54, 4, v54
    v_mul_u32_u24 v52, 3584, v63
    s_mul_i32 s47, s36, 448
    s_add_u32 s47, s47, s40
    s_lshl_b32 s47, s47, 7
    s_add_u32 s47, s47, 1792
    v_add3_u32 v52, v52, v54, s47
    s_mov_b32 s10, 1605632
    s_mov_b32 s11, 0x20000
    v_add_u32 v53, 27648, v52
    s_mul_i32 s61, s69, 229376
    s_lshl_b32 s68, s36, 11
    s_mov_b32 m0, s68
    s_nop 0
    buffer_load_dwordx4 v52, s[8:11], s61 offen  lds
    buffer_load_dwordx4 v53, s[8:11], s61 offen offset:1024  lds
    s_add_u32 s69, s69, 1
    s_cmp_eq_u32 s69, 7
    s_cselect_b32 s69, 0, s69
    s_mul_i32 s62, s69, 229376
    s_add_u32 s45, s48, s69
    s_lshl_b32 s55, s45, 7
    s_add_u32 m0, s68, 8192
    s_nop 0
    buffer_load_dwordx4 v52, s[8:11], s62 offen  lds
    buffer_load_dwordx4 v53, s[8:11], s62 offen offset:1024  lds
    s_load_dword s43, s[12:13], 0
    s_load_dwordx2 s[20:21], s[0:1], 32
    s_load_dwordx2 s[32:33], s[0:1], 40
    s_load_dwordx2 s[34:35], s[0:1], 72
    s_load_dwordx2 s[24:25], s[0:1], 80
    s_load_dwordx2 s[28:29], s[0:1], 96
    s_add_u32 s69, s69, 1
    s_cmp_eq_u32 s69, 7
    s_cselect_b32 s69, 0, s69
    s_mul_i32 s63, s69, 229376
    s_add_u32 s45, s48, s69
    s_lshl_b32 s56, s45, 7
    s_add_u32 s69, s69, 1
    s_cmp_eq_u32 s69, 7
    s_cselect_b32 s69, 0, s69
    s_mul_i32 s64, s69, 229376
    s_add_u32 s45, s48, s69
    s_lshl_b32 s57, s45, 7
    s_add_u32 s69, s69, 1
    s_cmp_eq_u32 s69, 7
    s_cselect_b32 s69, 0, s69
    s_mul_i32 s65, s69, 229376
    s_add_u32 s45, s48, s69
    s_lshl_b32 s58, s45, 7
    s_add_u32 s69, s69, 1
    s_cmp_eq_u32 s69, 7
    s_cselect_b32 s69, 0, s69
    s_mul_i32 s66, s69, 229376
    s_add_u32 s45, s48, s69
    s_lshl_b32 s59, s45, 7
    s_add_u32 s69, s69, 1
    s_cmp_eq_u32 s69, 7
    s_cselect_b32 s69, 0, s69
    s_mul_i32 s67, s69, 229376
    s_add_u32 s45, s48, s69
    s_lshl_b32 s60, s45, 7
    s_mov_b32 s22, 1835008
    s_mov_b32 s23, 0x20000
    s_mov_b32 s18, 8388608
    s_mov_b32 s19, 0x20000
    s_mov_b32 s26, 802816
    s_mov_b32 s27, 0x20000
    s_mov_b32 s30, 1835008
    s_mov_b32 s31, 0x20000
    s_mov_b32 s14, 25165824
    s_mov_b32 s15, 0x20000
    s_lshl1_add_u32 s41, s39, s38
    s_lshl_b32 s45, s37, 5
    s_add_u32 s42, s45, s41
    v_lshl_add_u32 v68, v69, 12, v68
    v_xor_b32 v69, 64, v68
    v_add_u32 v70, 14336, v68
    v_add_u32 v71, 78848, v69
    v_add_u32 v69, 64512, v69
    v_and_b32 v1, 15, v0
    v_lshrrev_b32 v3, 1, v1
    v_lshrrev_b32 v2, 4, v0
    v_xor_b32 v2, v2, v3
    v_lshlrev_b32 v2, 4, v2
    v_lshl_add_u32 v2, v1, 7, v2
    v_add_u32 v76, s53, v2
    v_xor_b32 v77, 64, v76
    v_lshrrev_b32 v2, 5, v0
    v_xor_b32 v2, v2, v3
    v_lshlrev_b32 v2, 4, v2
    v_lshl_add_u32 v2, v1, 7, v2
    v_bfe_u32 v3, v0, 4, 1
    v_lshl_add_u32 v2, v3, 3, v2
    v_add_u32 v72, s53, v2
    v_xor_b32 v73, 32, v72
    v_xor_b32 v74, 64, v72
    v_xor_b32 v75, 96, v72
    v_lshrrev_b32 v1, 2, v0
    v_bfe_u32 v2, v0, 3, 2
    v_lshlrev_b32 v2, 5, v2
    v_lshl_add_u32 v2, v1, 7, v2
    v_and_b32 v3, 3, v0
    v_lshl_add_u32 v48, v3, 3, v2
    v_xor_b32 v49, 32, v48
    v_xor_b32 v50, 64, v48
    v_xor_b32 v51, 96, v48
    v_lshlrev_b32 v58, 4, v0
    s_lshl2_add_u32 s45, s39, s36
    s_lshl_b32 s45, s45, 17
    s_lshl_b32 s46, s38, 11
    s_add_u32 s70, s45, s46
    s_mul_i32 s71, s37, 256
    s_cmp_eq_u32 s36, 0
    s_cselect_b32 s45, 0, 0x40000000
    v_cmp_gt_u32 vcc, 8, v0
    v_mov_b32 v1, 0x40000000
    v_mov_b32 v78, 0xc0135761
    v_mov_b32 v79, 0xc0135761
    v_cndmask_b32 v59, v1, v58, vcc
    s_lshl_b32 s46, s42, 7
    s_add_u32 s45, s45, s46
    v_add_u32 v59, s45, v59
    v_lshrrev_b32 v2, 5, v0
    v_lshl_add_u32 v80, v2, 30, v58
    s_lshl2_add_u32 s45, s39, s36
    s_lshl_b32 s45, s45, 12
    s_add_u32 s72, s45, 524288
    s_lshl_b32 s46, s40, 8
    v_lshl_add_u32 v55, v0, 2, s46
    s_lshl_b32 s45, s40, 18
    s_lshl2_add_u32 s46, s39, s36
    s_lshl_b32 s46, s46, 10
    s_add_u32 s45, s45, s46
    s_add_u32 s73, s45, 7340032
    s_lshr_b32 s46, s36, 1
    s_lshl1_add_u32 s46, s42, s46
    s_lshl_b32 s74, s46, 12
    s_lshl2_add_u32 s45, s42, s36
    s_lshl_b32 s46, s45, 12
    s_add_u32 s76, s46, 15728640
    s_xor_b32 s46, s46, 16384
    s_add_u32 s75, s46, 15728640
    s_mov_b32 s50, 0xbdd2d3e8
    s_mov_b32 s51, 0xbdd2d3e8
    s_lshl2_add_u32 s45, s39, s36
    s_lshl_b32 s45, s45, 6
    v_and_b32 v1, 12, v0
    v_and_b32 v2, 15, v0
    v_add_u32 v1, v1, v2
    v_lshl_add_u32 v57, v1, 1, s45
    s_lshl_b32 s46, s42, 2
    v_mov_b32 v60, s46
    s_lshl2_add_u32 s45, s41, s36
    s_mul_i32 s45, s45, 56
    s_add_u32 s45, s45, s37
    s_lshl_b32 s45, s45, 7
    v_mul_u32_u24 v62, 896, v63
    v_add3_u32 v62, v62, v54, s45
    s_waitcnt lgkmcnt(0)
    s_add_u32 s43, s43, 0x9E3779B9
    s_mov_b64 exec, 0
    s_cmp_eq_u32 s36, 1
    s_cbranch_scc1 L_pad1
    s_cmp_eq_u32 s36, 2
    s_cbranch_scc1 L_pad2
    s_cmp_eq_u32 s36, 3
    s_cbranch_scc1 L_pad3
    s_branch L_pad0
L_warm:
    s_mov_b64 exec, -1
    s_add_u32 m0, s53, 4096
    s_nop 0
    buffer_load_dwordx4 v64, s[4:7], s55 offen  lds
    buffer_load_dwordx4 v65, s[4:7], s55 offen offset:1024  lds
    buffer_load_dwordx4 v66, s[4:7], s55 offen offset:2048  lds
    buffer_load_dwordx4 v67, s[4:7], s55 offen offset:3072  lds
    s_add_u32 m0, s68, 16384
    s_nop 0
    buffer_load_dwordx4 v52, s[8:11], s63 offen  lds
    buffer_load_dwordx4 v53, s[8:11], s63 offen offset:1024  lds
    s_add_u32 m0, s53, 8192
    s_nop 0
    buffer_load_dwordx4 v64, s[4:7], s56 offen  lds
    buffer_load_dwordx4 v65, s[4:7], s56 offen offset:1024  lds
    buffer_load_dwordx4 v66, s[4:7], s56 offen offset:2048  lds
    buffer_load_dwordx4 v67, s[4:7], s56 offen offset:3072  lds
    s_branch L_body
L_slow_1:
    s_mov_b32 s49, 0
L_slow_1_l:
    buffer_load_dwordx4 v[228:231], v58, s[12:15], s72 offen offset:0 sc1
    buffer_load_dwordx4 v[232:235], v58, s[12:15], s72 offen offset:1024 sc1
    buffer_load_dwordx4 v[236:239], v58, s[12:15], s72 offen offset:2048 sc1
    buffer_load_dwordx4 v[240:243], v80, s[12:15], s72 offen offset:3072 sc1
    s_waitcnt vmcnt(0)
    v_xor_b32 v228, v228, v248
    v_xor_b32 v229, v229, v249
    v_xor_b32 v230, v230, v250
    v_xor_b32 v231, v231, v251
    v_xor_b32 v232, v232, v248
    v_xor_b32 v233, v233, v249
    v_xor_b32 v234, v234, v250
    v_xor_b32 v235, v235, v251
    v_xor_b32 v236, v236, v248
    v_xor_b32 v237, v237, v249
    v_xor_b32 v238, v238, v250
    v_xor_b32 v239, v239, v251
    s_mov_b32 exec_hi, 0
    v_xor_b32 v240, v240, v248
    v_xor_b32 v241, v241, v249
    v_xor_b32 v242, v242, v250
    v_xor_b32 v243, v243, v251
    s_mov_b32 exec_hi, -1
    v_or_b32 v1, v228, v229
    v_or3_b32 v1, v1, v230, v231
    v_or3_b32 v1, v1, v232, v233
    v_or3_b32 v1, v1, v234, v235
    v_or3_b32 v1, v1, v236, v237
    v_or3_b32 v1, v1, v238, v239
    v_or3_b32 v1, v1, v240, v241
    v_or3_b32 v1, v1, v242, v243
    v_and_b32 v1, 15, v1
    v_cmp_ne_u32 vcc, 0, v1
    s_nop 4
    s_cbranch_vccz L_back_2
    s_add_u32 s49, s49, 1
    s_cmp_lt_u32 s49, 20000
    s_cbranch_scc1 L_slow_1_l
    s_branch L_back_2
L_slow_3:
    s_mov_b32 s49, 0
L_slow_3_l:
    s_add_u32 s52, s86, 65536
    buffer_load_dword v61, v80, s[12:15], s52 offen sc1
    s_waitcnt vmcnt(0)
    v_cmp_ne_u32 vcc, s43, v61
    s_nop 4
    s_cbranch_vccz L_back_4
    s_add_u32 s49, s49, 1
    s_cmp_lt_u32 s49, 20000
    s_cbranch_scc1 L_slow_3_l
    s_branch L_back_4
L_slow_5:
    s_mov_b32 s49, 0
L_slow_5_l:
    s_add_u32 s52, s87, 65536
    buffer_load_dword v61, v80, s[12:15], s52 offen sc1
    s_waitcnt vmcnt(0)
    v_cmp_ne_u32 vcc, s43, v61
    s_nop 4
    s_cbranch_vccz L_back_6
    s_add_u32 s49, s49, 1
    s_cmp_lt_u32 s49, 20000
    s_cbranch_scc1 L_slow_5_l
    s_branch L_back_6
L_slow_7:
    s_mov_b32 s49, 0
L_slow_7_l:
    s_mov_b32 s86, 131072
    buffer_load_dword v61, v80, s[12:15], s86 offen sc1
    s_waitcnt vmcnt(0)
    v_cmp_ne_u32 vcc, s43, v61
    s_nop 4
    s_cbranch_vccz L_back_8
    s_add_u32 s49, s49, 1
    s_cmp_lt_u32 s49, 20000
    s_cbranch_scc1 L_slow_7_l
    s_branch L_back_8
L_slow_9:
    s_mov_b32 s49, 0
L_slow_9_l:
    buffer_load_dwordx4 v[88:91], v58, s[12:15], s76 offen offset:0 sc1
    buffer_load_dwordx4 v[96:99], v58, s[12:15], s76 offen offset:1024 sc1
    s_waitcnt vmcnt(0)
    v_xor_b32 v1, v88, v72
    v_bitop3_b32 v1, v1, v89, v73 bitop3:0xf6
    v_bitop3_b32 v1, v1, v90, v74 bitop3:0xf6
    v_bitop3_b32 v1, v1, v91, v75 bitop3:0xf6
    v_bitop3_b32 v1, v1, v96, v72 bitop3:0xf6
    v_bitop3_b32 v1, v1, v97, v73 bitop3:0xf6
    v_bitop3_b32 v1, v1, v98, v74 bitop3:0xf6
    v_bitop3_b32 v1, v1, v99, v75 bitop3:0xf6
    v_and_b32 v1, 0x00010001, v1
    v_cmp_ne_u32 vcc, 0, v1
    s_nop 4
    s_cbranch_vccz L_back_10
    s_add_u32 s49, s49, 1
    s_cmp_lt_u32 s49, 20000
    s_cbranch_scc1 L_slow_9_l
    s_branch L_back_10
L_slow_11:
    s_mov_b32 s49, 0
L_slow_11_l:
    buffer_load_dwordx4 v[104:107], v58, s[12:15], s76 offen offset:2048 sc1
    buffer_load_dwordx4 v[112:115], v58, s[12:15], s76 offen offset:3072 sc1
    s_waitcnt vmcnt(0)
    v_xor_b32 v1, v104, v72
    v_bitop3_b32 v1, v1, v105, v73 bitop3:0xf6
    v_bitop3_b32 v1, v1, v106, v74 bitop3:0xf6
    v_bitop3_b32 v1, v1, v107, v75 bitop3:0xf6
    v_bitop3_b32 v1, v1, v112, v72 bitop3:0xf6
    v_bitop3_b32 v1, v1, v113, v73 bitop3:0xf6
    v_bitop3_b32 v1, v1, v114, v74 bitop3:0xf6
    v_bitop3_b32 v1, v1, v115, v75 bitop3:0xf6
    v_and_b32 v1, 0x00010001, v1
    v_cmp_ne_u32 vcc, 0, v1
    s_nop 4
    s_cbranch_vccz L_back_12
    s_add_u32 s49, s49, 1
    s_cmp_lt_u32 s49, 20000
    s_cbranch_scc1 L_slow_11_l
    s_branch L_back_12
L_slow_13:
    s_mov_b32 s49, 0
L_slow_13_l:
    s_add_u32 s52, s60, 98304
    buffer_load_dword v61, v80, s[12:15], s52 offen sc1
    s_waitcnt vmcnt(0)
    v_cmp_ne_u32 vcc, s43, v61
    s_nop 4
    s_cbranch_vccz L_back_14
    s_add_u32 s49, s49, 1
    s_cmp_lt_u32 s49, 20000
    s_cbranch_scc1 L_slow_13_l
    s_branch L_back_14
L_slow_15:
    s_mov_b32 s49, 0
L_slow_15_l:
    s_mov_b32 s52, 32768
    buffer_load_dwordx2 v[48:49], v70, s[12:15], s52 offen sc1
    buffer_load_dword v32, v68, s[12:15], s59 offen offset:0 sc1
    buffer_load_dword v34, v68, s[12:15], s59 offen offset:128 sc1
    buffer_load_dword v36, v68, s[12:15], s59 offen offset:1024 sc1
    buffer_load_dword v38, v68, s[12:15], s59 offen offset:1152 sc1
    buffer_load_dword v40, v68, s[12:15], s59 offen offset:2048 sc1
    buffer_load_dword v42, v68, s[12:15], s59 offen offset:2176 sc1
    buffer_load_dword v44, v68, s[12:15], s59 offen offset:3072 sc1
    buffer_load_dword v46, v68, s[12:15], s59 offen offset:3200 sc1
    s_waitcnt vmcnt(0)
    v_xor_b32 v1, v32, v62
    v_bitop3_b32 v1, v1, v34, v62 bitop3:0xf6
    v_bitop3_b32 v1, v1, v36, v62 bitop3:0xf6
    v_bitop3_b32 v1, v1, v38, v62 bitop3:0xf6
    v_bitop3_b32 v1, v1, v40, v62 bitop3:0xf6
    v_bitop3_b32 v1, v1, v42, v62 bitop3:0xf6
    v_bitop3_b32 v1, v1, v44, v62 bitop3:0xf6
    v_bitop3_b32 v1, v1, v46, v62 bitop3:0xf6
    v_and_b32 v1, 0x00010001, v1
    v_bitop3_b32 v1, v1, v49, v4 bitop3:0xf6
    v_cmp_ne_u32 vcc, 0, v1
    s_nop 4
    s_cbranch_vccz L_back_16
    s_add_u32 s49, s49, 1
    s_cmp_lt_u32 s49, 20000
    s_cbranch_scc1 L_slow_15_l
    s_branch L_back_16
    .p2align 12
L_body:
L_pad0:
    s_cbranch_execz L_pad4
    s_waitcnt vmcnt(14)
    ds_read_b64 v[84:85], v72 offset:0
    ds_read_b64 v[86:87], v73 offset:0
    ds_read_b64 v[88:89], v72 offset:2048
    ds_read_b64 v[90:91], v73 offset:2048
    ds_read_b64 v[92:93], v74 offset:0
    ds_read_b64 v[94:95], v75 offset:0
    ds_read_b64 v[96:97], v74 offset:2048
    ds_read_b64 v[98:99], v75 offset:2048
    v_mov_b32 v4, s43
    v_mov_b32 v5, s43
    v_mov_b32 v6, s43
    v_mov_b32 v7, s43
    s_lshl_b32 s45, s44, 1
    s_sub_i32 s45, 5, s45
    s_max_i32 s45, s45, 0
    s_lshl1_add_u32 s45, s45, s38
    s_lshl_b32 s45, s45, 11
    v_add_u32 v16, s45, v72
    v_add_u32 v17, s45, v73
    v_add_u32 v18, s45, v74
    v_add_u32 v19, s45, v75
    s_waitcnt vmcnt(10)
    s_barrier
    ds_read_b64_tr_b16 a[224:225], v48 offset:0
    ds_read_b64_tr_b16 a[226:227], v48 offset:2048
    ds_read_b64_tr_b16 a[228:229], v49 offset:0
    ds_read_b64_tr_b16 a[230:231], v49 offset:2048
    ds_read_b64_tr_b16 a[232:233], v50 offset:0
    ds_read_b64_tr_b16 a[234:235], v50 offset:2048
    ds_read_b64_tr_b16 a[236:237], v51 offset:0
    ds_read_b64_tr_b16 a[238:239], v51 offset:2048
    ds_read_b64_tr_b16 a[240:241], v48 offset:4096
    ds_read_b64_tr_b16 a[242:243], v48 offset:6144
    ds_read_b64_tr_b16 a[244:245], v49 offset:4096
    ds_read_b64_tr_b16 a[246:247], v49 offset:6144
    s_waitcnt lgkmcnt(15)
    s_waitcnt lgkmcnt(10)
    v_mfma_f32_16x16x32_bf16 v[196:199], v[84:87], a[224:227], 0
    s_add_u32 m0, s68, 24576
    ds_read_b64_tr_b16 a[248:249], v50 offset:4096
    buffer_load_dwordx4 v52, s[8:11], s64 offen  lds
    v_mfma_f32_16x16x32_bf16 v[212:215], v[88:91], a[224:227], 0
    s_waitcnt lgkmcnt(9)
    ds_read_b64_tr_b16 a[250:251], v50 offset:6144
    buffer_load_dwordx4 v53, s[8:11], s64 offen offset:1024  lds
    v_mfma_f32_16x16x32_bf16 v[200:203], v[84:87], a[228:231], 0
    s_waitcnt vmcnt(8)
    ds_read_b64_tr_b16 a[252:253], v51 offset:4096
    ds_read_b64 v[100:101], v72 offset:4096
    v_mfma_f32_16x16x32_bf16 v[216:219], v[88:91], a[228:231], 0
    s_waitcnt lgkmcnt(10)
    ds_read_b64_tr_b16 a[254:255], v51 offset:6144
    ds_read_b64 v[102:103], v73 offset:4096
    v_mfma_f32_16x16x32_bf16 v[204:207], v[84:87], a[232:235], 0
    s_add_u32 m0, s53, 12288
    ds_read_b64_tr_b16 a[224:225], v48 offset:8192
    ds_read_b64 v[104:105], v72 offset:6144
    v_mfma_f32_16x16x32_bf16 v[220:223], v[88:91], a[232:235], 0
    s_waitcnt lgkmcnt(12)
    ds_read_b64_tr_b16 a[226:227], v48 offset:10240
    ds_read_b64 v[106:107], v73 offset:6144
    v_mfma_f32_16x16x32_bf16 v[208:211], v[84:87], a[236:239], 0
    ds_read_b64_tr_b16 a[228:229], v49 offset:8192
    ds_read_b64 v[108:109], v74 offset:4096
    v_mfma_f32_16x16x32_bf16 v[224:227], v[88:91], a[236:239], 0
    s_waitcnt lgkmcnt(14)
    ds_read_b64_tr_b16 a[230:231], v49 offset:10240
    ds_read_b64 v[110:111], v75 offset:4096
    v_mfma_f32_16x16x32_bf16 v[196:199], v[92:95], a[240:243], v[196:199]
    ds_read_b64_tr_b16 a[232:233], v50 offset:8192
    ds_read_b64 v[112:113], v74 offset:6144
    v_mfma_f32_16x16x32_bf16 v[212:215], v[96:99], a[240:243], v[212:215]
    s_waitcnt lgkmcnt(15)
    ds_read_b64_tr_b16 a[234:235], v50 offset:10240
    ds_read_b64 v[114:115], v75 offset:6144
    v_mfma_f32_16x16x32_bf16 v[200:203], v[92:95], a[244:247], v[200:203]
    ds_read_b64_tr_b16 a[236:237], v51 offset:8192
    buffer_load_dwordx4 v64, s[4:7], s57 offen  lds
    v_mfma_f32_16x16x32_bf16 v[216:219], v[96:99], a[244:247], v[216:219]
    s_waitcnt lgkmcnt(15)
    ds_read_b64_tr_b16 a[238:239], v51 offset:10240
    buffer_load_dwordx4 v65, s[4:7], s57 offen offset:1024  lds
    v_mfma_f32_16x16x32_bf16 v[204:207], v[92:95], a[248:251], v[204:207]
    ds_read_b64_tr_b16 a[240:241], v48 offset:12288
    buffer_load_dwordx4 v66, s[4:7], s57 offen offset:2048  lds
    v_mfma_f32_16x16x32_bf16 v[220:223], v[96:99], a[248:251], v[220:223]
    s_waitcnt lgkmcnt(15)
    ds_read_b64_tr_b16 a[242:243], v48 offset:14336
    buffer_load_dwordx4 v67, s[4:7], s57 offen offset:3072  lds
    v_mfma_f32_16x16x32_bf16 v[208:211], v[92:95], a[252:255], v[208:211]
    ds_read_b64_tr_b16 a[244:245], v49 offset:12288
    v_mfma_f32_16x16x32_bf16 v[224:227], v[96:99], a[252:255], v[224:227]
    s_waitcnt lgkmcnt(13)
    ds_read_b64_tr_b16 a[246:247], v49 offset:14336
    v_mfma_f32_16x16x32_bf16 v[196:199], v[100:103], a[224:227], v[196:199]
    s_add_u32 m0, s68, 32768
    ds_read_b64_tr_b16 a[248:249], v50 offset:12288
    buffer_load_dwordx4 v52, s[8:11], s65 offen  lds
    v_mfma_f32_16x16x32_bf16 v[212:215], v[104:107], a[224:227], v[212:215]
    s_waitcnt lgkmcnt(12)
    ds_read_b64_tr_b16 a[250:251], v50 offset:14336
    buffer_load_dwordx4 v53, s[8:11], s65 offen offset:1024  lds
    v_mfma_f32_16x16x32_bf16 v[200:203], v[100:103], a[228:231], v[200:203]
    s_waitcnt vmcnt(8)
    ds_read_b64_tr_b16 a[252:253], v51 offset:12288
    ds_read_b64 v[116:117], v72 offset:8192
    v_mfma_f32_16x16x32_bf16 v[216:219], v[104:107], a[228:231], v[216:219]
    s_waitcnt lgkmcnt(11)
    ds_read_b64_tr_b16 a[254:255], v51 offset:14336
    ds_read_b64 v[118:119], v73 offset:8192
    v_mfma_f32_16x16x32_bf16 v[204:207], v[100:103], a[232:235], v[204:207]
    ds_read_b64 v[120:121], v72 offset:10240
    ds_read_b64 v[122:123], v73 offset:10240
    v_mfma_f32_16x16x32_bf16 v[220:223], v[104:107], a[232:235], v[220:223]
    s_waitcnt lgkmcnt(12)
    ds_read_b64 v[124:125], v74 offset:8192
    ds_read_b64 v[126:127], v75 offset:8192
    v_mfma_f32_16x16x32_bf16 v[208:211], v[100:103], a[236:239], v[208:211]
    s_barrier
    ds_read_b64_tr_b16 a[224:225], v48 offset:16384
    ds_read_b64_tr_b16 a[226:227], v48 offset:18432
    v_mfma_f32_16x16x32_bf16 v[224:227], v[104:107], a[236:239], v[224:227]
    s_waitcnt lgkmcnt(14)
    ds_read_b64_tr_b16 a[228:229], v49 offset:16384
    ds_read_b64_tr_b16 a[230:231], v49 offset:18432
    v_mfma_f32_16x16x32_bf16 v[196:199], v[108:111], a[240:243], v[196:199]
    s_add_u32 m0, s53, 16384
    ds_read_b64_tr_b16 a[232:233], v50 offset:16384
    ds_read_b64 v[128:129], v74 offset:10240
    v_mfma_f32_16x16x32_bf16 v[212:215], v[112:115], a[240:243], v[212:215]
    s_waitcnt lgkmcnt(15)
    ds_read_b64_tr_b16 a[234:235], v50 offset:18432
    ds_read_b64 v[130:131], v75 offset:10240
    v_mfma_f32_16x16x32_bf16 v[200:203], v[108:111], a[244:247], v[200:203]
    ds_read_b64_tr_b16 a[236:237], v51 offset:16384
    buffer_load_dwordx4 v64, s[4:7], s58 offen  lds
    v_mfma_f32_16x16x32_bf16 v[216:219], v[112:115], a[244:247], v[216:219]
    s_waitcnt lgkmcnt(15)
    ds_read_b64_tr_b16 a[238:239], v51 offset:18432
    buffer_load_dwordx4 v65, s[4:7], s58 offen offset:1024  lds
    v_mfma_f32_16x16x32_bf16 v[204:207], v[108:111], a[248:251], v[204:207]
    ds_read_b64_tr_b16 a[240:241], v48 offset:20480
    buffer_load_dwordx4 v66, s[4:7], s58 offen offset:2048  lds
    v_mfma_f32_16x16x32_bf16 v[220:223], v[112:115], a[248:251], v[220:223]
    s_waitcnt lgkmcnt(15)
    ds_read_b64_tr_b16 a[242:243], v48 offset:22528
    buffer_load_dwordx4 v67, s[4:7], s58 offen offset:3072  lds
    v_mfma_f32_16x16x32_bf16 v[208:211], v[108:111], a[252:255], v[208:211]
    ds_read_b64_tr_b16 a[244:245], v49 offset:20480
    v_mfma_f32_16x16x32_bf16 v[224:227], v[112:115], a[252:255], v[224:227]
    s_waitcnt lgkmcnt(11)
    ds_read_b64_tr_b16 a[246:247], v49 offset:22528
    v_mfma_f32_16x16x32_bf16 v[196:199], v[116:119], a[224:227], v[196:199]
    s_add_u32 m0, s68, 40960
    ds_read_b64_tr_b16 a[248:249], v50 offset:20480
    buffer_load_dwordx4 v52, s[8:11], s66 offen  lds
    v_mfma_f32_16x16x32_bf16 v[212:215], v[120:123], a[224:227], v[212:215]
    s_waitcnt lgkmcnt(11)
    ds_read_b64_tr_b16 a[250:251], v50 offset:22528
    buffer_load_dwordx4 v53, s[8:11], s66 offen offset:1024  lds
    v_mfma_f32_16x16x32_bf16 v[200:203], v[116:119], a[228:231], v[200:203]
    s_waitcnt vmcnt(8)
    ds_read_b64_tr_b16 a[252:253], v51 offset:20480
    ds_read_b64 v[132:133], v72 offset:12288
    v_mfma_f32_16x16x32_bf16 v[216:219], v[120:123], a[228:231], v[216:219]
    s_waitcnt lgkmcnt(11)
    ds_read_b64_tr_b16 a[254:255], v51 offset:22528
    ds_read_b64 v[134:135], v73 offset:12288
    v_mfma_f32_16x16x32_bf16 v[204:207], v[116:119], a[232:235], v[204:207]
    ds_read_b64 v[136:137], v72 offset:14336
    ds_read_b64 v[138:139], v73 offset:14336
    v_mfma_f32_16x16x32_bf16 v[220:223], v[120:123], a[232:235], v[220:223]
    s_waitcnt lgkmcnt(12)
    ds_read_b64 v[140:141], v74 offset:12288
    ds_read_b64 v[142:143], v75 offset:12288
    v_mfma_f32_16x16x32_bf16 v[208:211], v[116:119], a[236:239], v[208:211]
    s_barrier
    ds_read_b64_tr_b16 a[224:225], v48 offset:24576
    ds_read_b64_tr_b16 a[226:227], v48 offset:26624
    v_mfma_f32_16x16x32_bf16 v[224:227], v[120:123], a[236:239], v[224:227]
    s_waitcnt lgkmcnt(14)
    ds_read_b64_tr_b16 a[228:229], v49 offset:24576
    ds_read_b64_tr_b16 a[230:231], v49 offset:26624
    v_mfma_f32_16x16x32_bf16 v[196:199], v[124:127], a[240:243], v[196:199]
    s_add_u32 m0, s53, 20480
    ds_read_b64_tr_b16 a[232:233], v50 offset:24576
    ds_read_b64 v[144:145], v74 offset:14336
    v_mfma_f32_16x16x32_bf16 v[212:215], v[128:131], a[240:243], v[212:215]
    s_waitcnt lgkmcnt(15)
    ds_read_b64_tr_b16 a[234:235], v50 offset:26624
    ds_read_b64 v[146:147], v75 offset:14336
    v_mfma_f32_16x16x32_bf16 v[200:203], v[124:127], a[244:247], v[200:203]
    ds_read_b64_tr_b16 a[236:237], v51 offset:24576
    buffer_load_dwordx4 v64, s[4:7], s59 offen  lds
    v_mfma_f32_16x16x32_bf16 v[216:219], v[128:131], a[244:247], v[216:219]
    s_waitcnt lgkmcnt(15)
    ds_read_b64_tr_b16 a[238:239], v51 offset:26624
    buffer_load_dwordx4 v65, s[4:7], s59 offen offset:1024  lds
    v_mfma_f32_16x16x32_bf16 v[204:207], v[124:127], a[248:251], v[204:207]
    ds_read_b64_tr_b16 a[240:241], v48 offset:28672
    buffer_load_dwordx4 v66, s[4:7], s59 offen offset:2048  lds
    v_mfma_f32_16x16x32_bf16 v[220:223], v[128:131], a[248:251], v[220:223]
    s_waitcnt lgkmcnt(15)
    ds_read_b64_tr_b16 a[242:243], v48 offset:30720
    buffer_load_dwordx4 v67, s[4:7], s59 offen offset:3072  lds
    v_mfma_f32_16x16x32_bf16 v[208:211], v[124:127], a[252:255], v[208:211]
    ds_read_b64_tr_b16 a[244:245], v49 offset:28672
    v_mfma_f32_16x16x32_bf16 v[224:227], v[128:131], a[252:255], v[224:227]
    s_waitcnt lgkmcnt(11)
    ds_read_b64_tr_b16 a[246:247], v49 offset:30720
    v_mfma_f32_16x16x32_bf16 v[196:199], v[132:135], a[224:227], v[196:199]
    s_add_u32 m0, s68, 49152
    ds_read_b64_tr_b16 a[248:249], v50 offset:28672
    buffer_load_dwordx4 v52, s[8:11], s67 offen  lds
    v_mfma_f32_16x16x32_bf16 v[212:215], v[136:139], a[224:227], v[212:215]
    s_waitcnt lgkmcnt(11)
    ds_read_b64_tr_b16 a[250:251], v50 offset:30720
    buffer_load_dwordx4 v53, s[8:11], s67 offen offset:1024  lds
    v_mfma_f32_16x16x32_bf16 v[200:203], v[132:135], a[228:231], v[200:203]
    s_waitcnt vmcnt(8)
    ds_read_b64_tr_b16 a[252:253], v51 offset:28672
    ds_read_b64 v[148:149], v72 offset:16384
    v_mfma_f32_16x16x32_bf16 v[216:219], v[136:139], a[228:231], v[216:219]
    s_waitcnt lgkmcnt(11)
    ds_read_b64_tr_b16 a[254:255], v51 offset:30720
    ds_read_b64 v[150:151], v73 offset:16384
    v_mfma_f32_16x16x32_bf16 v[204:207], v[132:135], a[232:235], v[204:207]
    ds_read_b64 v[152:153], v72 offset:18432
    ds_read_b64 v[154:155], v73 offset:18432
    v_mfma_f32_16x16x32_bf16 v[220:223], v[136:139], a[232:235], v[220:223]
    s_waitcnt lgkmcnt(12)
    ds_read_b64 v[156:157], v74 offset:16384
    ds_read_b64 v[158:159], v75 offset:16384
    v_mfma_f32_16x16x32_bf16 v[208:211], v[132:135], a[236:239], v[208:211]
    s_barrier
    ds_read_b64_tr_b16 a[224:225], v48 offset:32768
    ds_read_b64_tr_b16 a[226:227], v48 offset:34816
    v_mfma_f32_16x16x32_bf16 v[224:227], v[136:139], a[236:239], v[224:227]
    s_waitcnt lgkmcnt(14)
    ds_read_b64_tr_b16 a[228:229], v49 offset:32768
    ds_read_b64_tr_b16 a[230:231], v49 offset:34816
    v_mfma_f32_16x16x32_bf16 v[196:199], v[140:143], a[240:243], v[196:199]
    s_mov_b32 m0, s53
    ds_read_b64_tr_b16 a[232:233], v50 offset:32768
    ds_read_b64 v[160:161], v74 offset:18432
    v_mfma_f32_16x16x32_bf16 v[212:215], v[144:147], a[240:243], v[212:215]
    s_waitcnt lgkmcnt(15)
    ds_read_b64_tr_b16 a[234:235], v50 offset:34816
    ds_read_b64 v[162:163], v75 offset:18432
    v_mfma_f32_16x16x32_bf16 v[200:203], v[140:143], a[244:247], v[200:203]
    ds_read_b64_tr_b16 a[236:237], v51 offset:32768
    buffer_load_dwordx4 v64, s[4:7], s60 offen  lds
    v_mfma_f32_16x16x32_bf16 v[216:219], v[144:147], a[244:247], v[216:219]
    s_waitcnt lgkmcnt(15)
    ds_read_b64_tr_b16 a[238:239], v51 offset:34816
    buffer_load_dwordx4 v65, s[4:7], s60 offen offset:1024  lds
    v_mfma_f32_16x16x32_bf16 v[204:207], v[140:143], a[248:251], v[204:207]
    ds_read_b64_tr_b16 a[240:241], v48 offset:36864
    buffer_load_dwordx4 v66, s[4:7], s60 offen offset:2048  lds
    v_mfma_f32_16x16x32_bf16 v[220:223], v[144:147], a[248:251], v[220:223]
    s_waitcnt lgkmcnt(15)
    ds_read_b64_tr_b16 a[242:243], v48 offset:38912
    buffer_load_dwordx4 v67, s[4:7], s60 offen offset:3072  lds
    v_mfma_f32_16x16x32_bf16 v[208:211], v[140:143], a[252:255], v[208:211]
    ds_read_b64_tr_b16 a[244:245], v49 offset:36864
    v_subrev_u32 v52, 1792, v52
    v_mfma_f32_16x16x32_bf16 v[224:227], v[144:147], a[252:255], v[224:227]
    s_waitcnt lgkmcnt(11)
    ds_read_b64_tr_b16 a[246:247], v49 offset:38912
    v_subrev_u32 v53, 1792, v53
    v_mfma_f32_16x16x32_bf16 v[196:199], v[148:151], a[224:227], v[196:199]
    ds_read_b64_tr_b16 a[248:249], v50 offset:36864
    v_mfma_f32_16x16x32_bf16 v[212:215], v[152:155], a[224:227], v[212:215]
    s_waitcnt lgkmcnt(11)
    ds_read_b64_tr_b16 a[250:251], v50 offset:38912
    v_mfma_f32_16x16x32_bf16 v[200:203], v[148:151], a[228:231], v[200:203]
    s_waitcnt vmcnt(6)
    ds_read_b64_tr_b16 a[252:253], v51 offset:36864
    ds_read_b64 v[164:165], v72 offset:20480
    v_mfma_f32_16x16x32_bf16 v[216:219], v[152:155], a[228:231], v[216:219]
    s_waitcnt lgkmcnt(11)
    ds_read_b64_tr_b16 a[254:255], v51 offset:38912
    ds_read_b64 v[166:167], v73 offset:20480
    v_mfma_f32_16x16x32_bf16 v[204:207], v[148:151], a[232:235], v[204:207]
    ds_read_b64 v[168:169], v72 offset:22528
    ds_read_b64 v[170:171], v73 offset:22528
    v_mfma_f32_16x16x32_bf16 v[220:223], v[152:155], a[232:235], v[220:223]
    s_waitcnt lgkmcnt(12)
    ds_read_b64 v[172:173], v74 offset:20480
    ds_read_b64 v[174:175], v75 offset:20480
    v_mfma_f32_16x16x32_bf16 v[208:211], v[148:151], a[236:239], v[208:211]
    s_barrier
    ds_read_b64_tr_b16 a[224:225], v48 offset:40960
    ds_read_b64_tr_b16 a[226:227], v48 offset:43008
    v_mfma_f32_16x16x32_bf16 v[224:227], v[152:155], a[236:239], v[224:227]
    s_waitcnt lgkmcnt(14)
    ds_read_b64_tr_b16 a[228:229], v49 offset:40960
    ds_read_b64_tr_b16 a[230:231], v49 offset:43008
    v_mfma_f32_16x16x32_bf16 v[196:199], v[156:159], a[240:243], v[196:199]
    ds_read_b64_tr_b16 a[232:233], v50 offset:40960
    ds_read_b64 v[176:177], v74 offset:22528
    v_mfma_f32_16x16x32_bf16 v[212:215], v[160:163], a[240:243], v[212:215]
    s_waitcnt lgkmcnt(15)
    ds_read_b64_tr_b16 a[234:235], v50 offset:43008
    ds_read_b64 v[178:179], v75 offset:22528
    v_mfma_f32_16x16x32_bf16 v[200:203], v[156:159], a[244:247], v[200:203]
    ds_read_b64_tr_b16 a[236:237], v51 offset:40960
    v_mfma_f32_16x16x32_bf16 v[216:219], v[160:163], a[244:247], v[216:219]
    s_waitcnt lgkmcnt(15)
    ds_read_b64_tr_b16 a[238:239], v51 offset:43008
    v_mfma_f32_16x16x32_bf16 v[204:207], v[156:159], a[248:251], v[204:207]
    ds_read_b64_tr_b16 a[240:241], v48 offset:45056
    v_mfma_f32_16x16x32_bf16 v[220:223], v[160:163], a[248:251], v[220:223]
    s_waitcnt lgkmcnt(15)
    ds_read_b64_tr_b16 a[242:243], v48 offset:47104
    v_mfma_f32_16x16x32_bf16 v[208:211], v[156:159], a[252:255], v[208:211]
    ds_read_b64_tr_b16 a[244:245], v49 offset:45056
    v_mfma_f32_16x16x32_bf16 v[224:227], v[160:163], a[252:255], v[224:227]
    s_waitcnt lgkmcnt(11)
    ds_read_b64_tr_b16 a[246:247], v49 offset:47104
    v_mfma_f32_16x16x32_bf16 v[196:199], v[164:167], a[224:227], v[196:199]
    ds_read_b64_tr_b16 a[248:249], v50 offset:45056
    v_mfma_f32_16x16x32_bf16 v[212:215], v[168:171], a[224:227], v[212:215]
    s_waitcnt lgkmcnt(11)
    ds_read_b64_tr_b16 a[250:251], v50 offset:47104
    v_mfma_f32_16x16x32_bf16 v[200:203], v[164:167], a[228:231], v[200:203]
    s_waitcnt vmcnt(0)
    ds_read_b64_tr_b16 a[252:253], v51 offset:45056
    ds_read_b64 v[180:181], v72 offset:0
    v_mfma_f32_16x16x32_bf16 v[216:219], v[168:171], a[228:231], v[216:219]
    s_waitcnt lgkmcnt(11)
    ds_read_b64_tr_b16 a[254:255], v51 offset:47104
    ds_read_b64 v[182:183], v73 offset:0
    v_mfma_f32_16x16x32_bf16 v[204:207], v[164:167], a[232:235], v[204:207]
    ds_read_b64 v[184:185], v72 offset:2048
    ds_read_b64 v[186:187], v73 offset:2048
    v_mfma_f32_16x16x32_bf16 v[220:223], v[168:171], a[232:235], v[220:223]
    s_waitcnt lgkmcnt(12)
    ds_read_b64 v[188:189], v74 offset:0
    ds_read_b64 v[190:191], v75 offset:0
    v_mfma_f32_16x16x32_bf16 v[208:211], v[164:167], a[236:239], v[208:211]
    s_barrier
    ds_read_b64_tr_b16 a[224:225], v48 offset:49152
    ds_read_b64_tr_b16 a[226:227], v48 offset:51200
    v_mfma_f32_16x16x32_bf16 v[224:227], v[168:171], a[236:239], v[224:227]
    s_waitcnt lgkmcnt(14)
    ds_read_b64_tr_b16 a[228:229], v49 offset:49152
    ds_read_b64_tr_b16 a[230:231], v49 offset:51200
    v_mfma_f32_16x16x32_bf16 v[196:199], v[172:175], a[240:243], v[196:199]
    ds_read_b64_tr_b16 a[232:233], v50 offset:49152
    ds_read_b64 v[192:193], v74 offset:2048
    v_mfma_f32_16x16x32_bf16 v[212:215], v[176:179], a[240:243], v[212:215]
    s_waitcnt lgkmcnt(15)
    ds_read_b64_tr_b16 a[234:235], v50 offset:51200
    ds_read_b64 v[194:195], v75 offset:2048
    v_mfma_f32_16x16x32_bf16 v[200:203], v[172:175], a[244:247], v[200:203]
    ds_read_b64_tr_b16 a[236:237], v51 offset:49152
    ds_read_b64 v[8:9], v16
    v_mfma_f32_16x16x32_bf16 v[216:219], v[176:179], a[244:247], v[216:219]
    s_waitcnt lgkmcnt(15)
    ds_read_b64_tr_b16 a[238:239], v51 offset:51200
    ds_read_b64 v[10:11], v17
    v_mfma_f32_16x16x32_bf16 v[204:207], v[172:175], a[248:251], v[204:207]
    ds_read_b64_tr_b16 a[240:241], v48 offset:53248
    ds_read_b64 v[12:13], v18
    v_mfma_f32_16x16x32_bf16 v[220:223], v[176:179], a[248:251], v[220:223]
    ds_read_b64_tr_b16 a[242:243], v48 offset:55296
    ds_read_b64 v[14:15], v19
    v_mfma_f32_16x16x32_bf16 v[208:211], v[172:175], a[252:255], v[208:211]
    ds_read_b64_tr_b16 a[244:245], v49 offset:53248
    global_load_ushort v56, v57, s[34:35]
    v_mfma_f32_16x16x32_bf16 v[224:227], v[176:179], a[252:255], v[224:227]
    s_waitcnt lgkmcnt(15)
    ds_read_b64_tr_b16 a[246:247], v49 offset:55296
    global_load_ushort v57, v57, s[34:35] offset:8
    v_mfma_f32_16x16x32_bf16 v[196:199], v[180:183], a[224:227], v[196:199]
    ds_read_b64_tr_b16 a[248:249], v50 offset:53248
    global_load_dword v60, v60, s[32:33]
    v_mfma_f32_16x16x32_bf16 v[212:215], v[184:187], a[224:227], v[212:215]
    s_waitcnt lgkmcnt(15)
    ds_read_b64_tr_b16 a[250:251], v50 offset:55296
    s_lshl_b32 s47, s36, 10
    v_mfma_f32_16x16x32_bf16 v[200:203], v[180:183], a[228:231], v[200:203]
    s_add_u32 m0, s47, 159744
    ds_read_b64_tr_b16 a[252:253], v51 offset:53248
    buffer_load_dwordx4 v62, s[24:27], 0 offen  lds
    v_mfma_f32_16x16x32_bf16 v[216:219], v[184:187], a[228:231], v[216:219]
    s_waitcnt lgkmcnt(14)
    ds_read_b64_tr_b16 a[254:255], v51 offset:55296
    v_mfma_f32_16x16x32_bf16 v[204:207], v[180:183], a[232:235], v[204:207]
    v_mfma_f32_16x16x32_bf16 v[220:223], v[184:187], a[232:235], v[220:223]
    s_waitcnt lgkmcnt(11)
    s_mov_b32 m0, s68
    s_nop 0
    buffer_load_dwordx4 v52, s[8:11], s61 offen  lds
    v_mfma_f32_16x16x32_bf16 v[208:211], v[180:183], a[236:239], v[208:211]
    v_mfma_f32_16x16x32_bf16 v[224:227], v[184:187], a[236:239], v[224:227]
    s_waitcnt lgkmcnt(7)
    v_mfma_f32_16x16x32_bf16 v[196:199], v[188:191], a[240:243], v[196:199]
    buffer_load_dwordx4 v53, s[8:11], s61 offen offset:1024  lds
    v_mfma_f32_16x16x32_bf16 v[212:215], v[192:195], a[240:243], v[212:215]
    s_waitcnt lgkmcnt(4)
    v_mfma_f32_16x16x32_bf16 v[200:203], v[188:191], a[244:247], v[200:203]
    v_mfma_f32_16x16x32_bf16 v[216:219], v[192:195], a[244:247], v[216:219]
    s_waitcnt lgkmcnt(2)
    s_add_u32 m0, s68, 8192
    s_nop 0
    buffer_load_dwordx4 v52, s[8:11], s62 offen  lds
    v_mfma_f32_16x16x32_bf16 v[204:207], v[188:191], a[248:251], v[204:207]
    v_mfma_f32_16x16x32_bf16 v[220:223], v[192:195], a[248:251], v[220:223]
    s_waitcnt lgkmcnt(0)
    v_mfma_f32_16x16x32_bf16 v[208:211], v[188:191], a[252:255], v[208:211]
    buffer_load_dwordx4 v53, s[8:11], s62 offen offset:1024  lds
    v_mfma_f32_16x16x32_bf16 v[224:227], v[192:195], a[252:255], v[224:227]
    s_add_u32 m0, s53, 8192
    s_add_u32 s47, s70, s71
    buffer_load_dwordx4 v68, s[16:19], s47 offen  lds
    s_add_u32 s71, s71, 256
    buffer_load_dwordx4 v69, s[16:19], s47 offen offset:1024  lds
    s_and_b32 s71, s71, 2047
    buffer_load_dwordx4 v70, s[16:19], s47 offen offset:2048  lds
    buffer_load_dwordx4 v71, s[16:19], s47 offen offset:3072  lds
    s_barrier
    v_and_b32 v2, 7, v0
    v_lshlrev_b32 v2, 2, v2
    v_bfe_u32 v2, v4, v2, 4
    v_pk_mul_f32 v[228:229], v[196:197], v[196:197]
    v_pk_mul_f32 v[230:231], v[198:199], v[198:199]
    v_pk_mul_f32 v[232:233], v[200:201], v[200:201]
    v_pk_mul_f32 v[234:235], v[202:203], v[202:203]
    v_pk_fma_f32 v[228:229], v[228:229], s[50:51], v[78:79]
    v_pk_fma_f32 v[230:231], v[230:231], s[50:51], v[78:79]
    v_pk_fma_f32 v[232:233], v[232:233], s[50:51], v[78:79]
    v_pk_fma_f32 v[234:235], v[234:235], s[50:51], v[78:79]
    v_pk_mul_f32 v[228:229], v[228:229], v[196:197]
    v_pk_mul_f32 v[230:231], v[230:231], v[198:199]
    v_pk_mul_f32 v[232:233], v[232:233], v[200:201]
    v_pk_mul_f32 v[234:235], v[234:235], v[202:203]
    v_exp_f32 v228, v228
    v_exp_f32 v229, v229
    v_exp_f32 v230, v230
    v_exp_f32 v231, v231
    v_exp_f32 v232, v232
    v_exp_f32 v233, v233
    v_exp_f32 v234, v234
    v_exp_f32 v235, v235
    v_pk_add_f32 v[228:229], v[228:229], 1.0 op_sel_hi:[1,0]
    v_pk_add_f32 v[230:231], v[230:231], 1.0 op_sel_hi:[1,0]
    v_pk_add_f32 v[232:233], v[232:233], 1.0 op_sel_hi:[1,0]
    v_pk_add_f32 v[234:235], v[234:235], 1.0 op_sel_hi:[1,0]
    v_rcp_f32 v228, v228
    v_rcp_f32 v229, v229
    v_rcp_f32 v230, v230
    v_rcp_f32 v231, v231
    v_rcp_f32 v232, v232
    v_rcp_f32 v233, v233
    v_rcp_f32 v234, v234
    v_rcp_f32 v235, v235
    v_pk_mul_f32 v[196:197], v[228:229], v[196:197]
    v_pk_mul_f32 v[198:199], v[230:231], v[198:199]
    v_pk_mul_f32 v[200:201], v[232:233], v[200:201]
    v_pk_mul_f32 v[202:203], v[234:235], v[202:203]
    v_pk_mul_f32 v[228:229], v[204:205], v[204:205]
    v_pk_mul_f32 v[230:231], v[206:207], v[206:207]
    v_pk_mul_f32 v[232:233], v[208:209], v[208:209]
    v_pk_mul_f32 v[234:235], v[210:211], v[210:211]
    v_pk_fma_f32 v[228:229], v[228:229], s[50:51], v[78:79]
    v_pk_fma_f32 v[230:231], v[230:231], s[50:51], v[78:79]
    v_pk_fma_f32 v[232:233], v[232:233], s[50:51], v[78:79]
    v_pk_fma_f32 v[234:235], v[234:235], s[50:51], v[78:79]
    v_pk_mul_f32 v[228:229], v[228:229], v[204:205]
    v_pk_mul_f32 v[230:231], v[230:231], v[206:207]
    v_pk_mul_f32 v[232:233], v[232:233], v[208:209]
    v_pk_mul_f32 v[234:235], v[234:235], v[210:211]
    v_exp_f32 v228, v228
    v_exp_f32 v229, v229
    v_exp_f32 v230, v230
    v_exp_f32 v231, v231
    v_exp_f32 v232, v232
    v_exp_f32 v233, v233
    v_exp_f32 v234, v234
    v_exp_f32 v235, v235
    v_pk_add_f32 v[228:229], v[228:229], 1.0 op_sel_hi:[1,0]
    v_pk_add_f32 v[230:231], v[230:231], 1.0 op_sel_hi:[1,0]
    v_pk_add_f32 v[232:233], v[232:233], 1.0 op_sel_hi:[1,0]
    v_pk_add_f32 v[234:235], v[234:235], 1.0 op_sel_hi:[1,0]
    v_rcp_f32 v228, v228
    v_rcp_f32 v229, v229
    v_rcp_f32 v230, v230
    v_rcp_f32 v231, v231
    v_rcp_f32 v232, v232
    v_rcp_f32 v233, v233
    v_rcp_f32 v234, v234
    v_rcp_f32 v235, v235
    v_pk_mul_f32 v[204:205], v[228:229], v[204:205]
    v_pk_mul_f32 v[206:207], v[230:231], v[206:207]
    v_pk_mul_f32 v[208:209], v[232:233], v[208:209]
    v_pk_mul_f32 v[210:211], v[234:235], v[210:211]
    v_pk_mul_f32 v[228:229], v[212:213], v[212:213]
    v_pk_mul_f32 v[230:231], v[214:215], v[214:215]
    v_pk_mul_f32 v[232:233], v[216:217], v[216:217]
    v_pk_mul_f32 v[234:235], v[218:219], v[218:219]
    v_pk_fma_f32 v[228:229], v[228:229], s[50:51], v[78:79]
    v_pk_fma_f32 v[230:231], v[230:231], s[50:51], v[78:79]
    v_pk_fma_f32 v[232:233], v[232:233], s[50:51], v[78:79]
    v_pk_fma_f32 v[234:235], v[234:235], s[50:51], v[78:79]
    v_pk_mul_f32 v[228:229], v[228:229], v[212:213]
    v_pk_mul_f32 v[230:231], v[230:231], v[214:215]
    v_pk_mul_f32 v[232:233], v[232:233], v[216:217]
    v_pk_mul_f32 v[234:235], v[234:235], v[218:219]
    v_exp_f32 v228, v228
    v_exp_f32 v229, v229
    v_exp_f32 v230, v230
    v_exp_f32 v231, v231
    v_exp_f32 v232, v232
    v_exp_f32 v233, v233
    v_exp_f32 v234, v234
    v_exp_f32 v235, v235
    v_pk_add_f32 v[228:229], v[228:229], 1.0 op_sel_hi:[1,0]
    v_pk_add_f32 v[230:231], v[230:231], 1.0 op_sel_hi:[1,0]
    v_pk_add_f32 v[232:233], v[232:233], 1.0 op_sel_hi:[1,0]
    v_pk_add_f32 v[234:235], v[234:235], 1.0 op_sel_hi:[1,0]
    v_rcp_f32 v228, v228
    v_rcp_f32 v229, v229
    v_rcp_f32 v230, v230
    v_rcp_f32 v231, v231
    v_rcp_f32 v232, v232
    v_rcp_f32 v233, v233
    v_rcp_f32 v234, v234
    v_rcp_f32 v235, v235
    v_pk_mul_f32 v[212:213], v[228:229], v[212:213]
    v_pk_mul_f32 v[214:215], v[230:231], v[214:215]
    v_pk_mul_f32 v[216:217], v[232:233], v[216:217]
    v_pk_mul_f32 v[218:219], v[234:235], v[218:219]
    v_pk_mul_f32 v[228:229], v[220:221], v[220:221]
    v_pk_mul_f32 v[230:231], v[222:223], v[222:223]
    v_pk_mul_f32 v[232:233], v[224:225], v[224:225]
    v_pk_mul_f32 v[234:235], v[226:227], v[226:227]
    v_pk_fma_f32 v[228:229], v[228:229], s[50:51], v[78:79]
    v_pk_fma_f32 v[230:231], v[230:231], s[50:51], v[78:79]
    v_pk_fma_f32 v[232:233], v[232:233], s[50:51], v[78:79]
    v_pk_fma_f32 v[234:235], v[234:235], s[50:51], v[78:79]
    v_pk_mul_f32 v[228:229], v[228:229], v[220:221]
    v_pk_mul_f32 v[230:231], v[230:231], v[222:223]
    v_pk_mul_f32 v[232:233], v[232:233], v[224:225]
    v_pk_mul_f32 v[234:235], v[234:235], v[226:227]
    v_exp_f32 v228, v228
    v_exp_f32 v229, v229
    v_exp_f32 v230, v230
    v_exp_f32 v231, v231
    v_exp_f32 v232, v232
    v_exp_f32 v233, v233
    v_exp_f32 v234, v234
    v_exp_f32 v235, v235
    v_pk_add_f32 v[228:229], v[228:229], 1.0 op_sel_hi:[1,0]
    v_pk_add_f32 v[230:231], v[230:231], 1.0 op_sel_hi:[1,0]
    v_pk_add_f32 v[232:233], v[232:233], 1.0 op_sel_hi:[1,0]
    v_pk_add_f32 v[234:235], v[234:235], 1.0 op_sel_hi:[1,0]
    v_rcp_f32 v228, v228
    v_rcp_f32 v229, v229
    v_rcp_f32 v230, v230
    v_rcp_f32 v231, v231
    v_rcp_f32 v232, v232
    v_rcp_f32 v233, v233
    v_rcp_f32 v234, v234
    v_rcp_f32 v235, v235
    v_pk_mul_f32 v[220:221], v[228:229], v[220:221]
    v_pk_mul_f32 v[222:223], v[230:231], v[222:223]
    v_pk_mul_f32 v[224:225], v[232:233], v[224:225]
    v_pk_mul_f32 v[226:227], v[234:235], v[226:227]
    v_pk_add_f32 v[16:17], v[196:197], v[200:201]
    v_pk_mul_f32 v[24:25], v[196:197], v[196:197]
    v_pk_add_f32 v[18:19], v[198:199], v[202:203]
    v_pk_mul_f32 v[26:27], v[198:199], v[198:199]
    v_pk_add_f32 v[20:21], v[212:213], v[216:217]
    v_pk_mul_f32 v[28:29], v[212:213], v[212:213]
    v_pk_add_f32 v[22:23], v[214:215], v[218:219]
    v_pk_mul_f32 v[30:31], v[214:215], v[214:215]
    v_pk_fma_f32 v[24:25], v[200:201], v[200:201], v[24:25]
    v_pk_fma_f32 v[26:27], v[202:203], v[202:203], v[26:27]
    v_pk_fma_f32 v[28:29], v[216:217], v[216:217], v[28:29]
    v_pk_fma_f32 v[30:31], v[218:219], v[218:219], v[30:31]
    v_pk_add_f32 v[16:17], v[16:17], v[204:205]
    v_pk_fma_f32 v[24:25], v[204:205], v[204:205], v[24:25]
    v_pk_add_f32 v[18:19], v[18:19], v[206:207]
    v_pk_fma_f32 v[26:27], v[206:207], v[206:207], v[26:27]
    v_pk_add_f32 v[20:21], v[20:21], v[220:221]
    v_pk_fma_f32 v[28:29], v[220:221], v[220:221], v[28:29]
    v_pk_add_f32 v[22:23], v[22:23], v[222:223]
L_pad1:
    s_cbranch_execz L_pad5
    v_pk_fma_f32 v[30:31], v[222:223], v[222:223], v[30:31]
    v_pk_add_f32 v[16:17], v[16:17], v[208:209]
    v_pk_fma_f32 v[24:25], v[208:209], v[208:209], v[24:25]
    v_pk_add_f32 v[18:19], v[18:19], v[210:211]
    v_pk_fma_f32 v[26:27], v[210:211], v[210:211], v[26:27]
    v_pk_add_f32 v[20:21], v[20:21], v[224:225]
    v_pk_fma_f32 v[28:29], v[224:225], v[224:225], v[28:29]
    v_pk_add_f32 v[22:23], v[22:23], v[226:227]
    v_pk_fma_f32 v[30:31], v[226:227], v[226:227], v[30:31]
    v_add_f32_dpp v32, v16, v16 row_mirror row_mask:0xf bank_mask:0x3
    v_add_f32_dpp v33, v17, v17 row_mirror row_mask:0xf bank_mask:0x3
    v_add_f32_dpp v34, v18, v18 row_mirror row_mask:0xf bank_mask:0x3
    v_add_f32_dpp v35, v19, v19 row_mirror row_mask:0xf bank_mask:0x3
    v_add_f32_dpp v36, v24, v24 row_mirror row_mask:0xf bank_mask:0x3
    v_add_f32_dpp v37, v25, v25 row_mirror row_mask:0xf bank_mask:0x3
    s_add_u32 m0, s68, 16384
    s_nop 0
    buffer_load_dwordx4 v52, s[8:11], s63 offen  lds
    buffer_load_dwordx4 v53, s[8:11], s63 offen offset:1024  lds
    v_add_f32_dpp v38, v26, v26 row_mirror row_mask:0xf bank_mask:0x3
    v_add_f32_dpp v39, v27, v27 row_mirror row_mask:0xf bank_mask:0x3
    v_add_f32_dpp v32, v20, v20 row_mirror row_mask:0xf bank_mask:0xc
    v_add_f32_dpp v33, v21, v21 row_mirror row_mask:0xf bank_mask:0xc
    v_add_f32_dpp v34, v22, v22 row_mirror row_mask:0xf bank_mask:0xc
    v_add_f32_dpp v35, v23, v23 row_mirror row_mask:0xf bank_mask:0xc
    v_add_f32_dpp v36, v28, v28 row_mirror row_mask:0xf bank_mask:0xc
    v_add_f32_dpp v37, v29, v29 row_mirror row_mask:0xf bank_mask:0xc
    v_add_f32_dpp v38, v30, v30 row_mirror row_mask:0xf bank_mask:0xc
    v_add_f32_dpp v39, v31, v31 row_mirror row_mask:0xf bank_mask:0xc
    v_add_f32_dpp v40, v32, v32 row_half_mirror row_mask:0xf bank_mask:0x5
    v_add_f32_dpp v41, v33, v33 row_half_mirror row_mask:0xf bank_mask:0x5
    v_add_f32_dpp v42, v36, v36 row_half_mirror row_mask:0xf bank_mask:0x5
    v_add_f32_dpp v43, v37, v37 row_half_mirror row_mask:0xf bank_mask:0x5
    v_add_f32_dpp v40, v34, v34 row_half_mirror row_mask:0xf bank_mask:0xa
    v_add_f32_dpp v41, v35, v35 row_half_mirror row_mask:0xf bank_mask:0xa
    v_add_f32_dpp v42, v38, v38 row_half_mirror row_mask:0xf bank_mask:0xa
    v_add_f32_dpp v43, v39, v39 row_half_mirror row_mask:0xf bank_mask:0xa
    v_add_f32_dpp v40, v40, v40 quad_perm:[1,0,3,2] row_mask:0xf bank_mask:0xf
    v_add_f32_dpp v41, v41, v41 quad_perm:[1,0,3,2] row_mask:0xf bank_mask:0xf
    v_add_f32_dpp v42, v42, v42 quad_perm:[1,0,3,2] row_mask:0xf bank_mask:0xf
    v_add_f32_dpp v43, v43, v43 quad_perm:[1,0,3,2] row_mask:0xf bank_mask:0xf
    v_add_f32_dpp v40, v40, v40 quad_perm:[2,3,0,1] row_mask:0xf bank_mask:0xf
    v_add_f32_dpp v41, v41, v41 quad_perm:[2,3,0,1] row_mask:0xf bank_mask:0xf
    v_add_f32_dpp v42, v42, v42 quad_perm:[2,3,0,1] row_mask:0xf bank_mask:0xf
    v_add_f32_dpp v43, v43, v43 quad_perm:[2,3,0,1] row_mask:0xf bank_mask:0xf
    s_mov_b32 vcc_lo, 0xaaaaaaaa
    s_mov_b32 vcc_hi, 0xaaaaaaaa
    v_cndmask_b32 v16, v40, v42, vcc
    v_cndmask_b32 v18, v41, v43, vcc
    s_mov_b32 vcc_lo, 0xcccccccc
    s_mov_b32 vcc_hi, 0xcccccccc
    v_cndmask_b32 v16, v16, v18, vcc
    v_and_or_b32 v16, v16, -16, v2
    buffer_store_dword v16, v55, s[12:15], s72 offen sc1
    v_and_b32 v2, 1, v0
    v_lshlrev_b32 v2, 4, v2
    v_lshrrev_b32 v2, v2, v4
    s_lshl_b32 s45, s36, 8
    s_add_u32 s45, s45, 155648
    v_and_b32 v1, 31, v0
    v_lshl_add_u32 v1, v1, 3, s45
    v_lshrrev_b32 v3, 5, v0
    v_lshl_add_u32 v252, v3, 2, v1
    v_and_b32 v1, 48, v0
    v_lshl_add_u32 v253, v1, 1, s45
    v_bfe_u32 v248, v2, 0, 4
    v_bfe_u32 v249, v2, 4, 4
    v_bfe_u32 v250, v2, 8, 4
    v_bfe_u32 v251, v2, 12, 4
    s_waitcnt vmcnt(11)
    s_barrier
    s_lshl_b32 s45, s36, 5
    v_xor_b32 v62, s45, v48
    v_add_u32 v62, 159744, v62
    ds_read_b64_tr_b16 v[20:21], v62
    ds_read_b64_tr_b16 v[22:23], v62 offset:2048
    s_mul_i32 s45, s37, 28
    s_add_u32 s45, s45, s41
    s_lshl2_add_u32 s45, s45, s36
    s_lshl_b32 s45, s45, 10
    s_cmp_lt_u32 s41, 28
    s_cselect_b32 s46, 24117248, 0x40000000
    s_add_u32 s45, s45, s46
    s_waitcnt lgkmcnt(0)
    buffer_store_dwordx4 v[20:23], v58, s[12:15], s45 offen sc1
    s_add_u32 m0, s68, 24576
    s_nop 0
    buffer_load_dwordx4 v52, s[8:11], s64 offen  lds
    buffer_load_dwordx4 v53, s[8:11], s64 offen offset:1024  lds
    s_add_u32 m0, s68, 32768
    s_nop 0
    buffer_load_dwordx4 v52, s[8:11], s65 offen  lds
    buffer_load_dwordx4 v53, s[8:11], s65 offen offset:1024  lds
    s_add_u32 m0, s68, 40960
    s_nop 0
    buffer_load_dwordx4 v52, s[8:11], s66 offen  lds
    buffer_load_dwordx4 v53, s[8:11], s66 offen offset:1024  lds
    s_add_u32 m0, s68, 49152
    s_nop 0
    buffer_load_dwordx4 v52, s[8:11], s67 offen  lds
    buffer_load_dwordx4 v53, s[8:11], s67 offen offset:1024  lds
    s_waitcnt vmcnt(12)
    ds_read_b128 a[0:3], v76 offset:8192
    ds_read_b128 a[4:7], v76 offset:10240
    ds_read_b128 a[8:11], v77 offset:8192
    ds_read_b128 a[12:15], v77 offset:10240
    buffer_load_dwordx4 v[228:231], v58, s[12:15], s72 offen offset:0 sc1
    buffer_load_dwordx4 v[232:235], v58, s[12:15], s72 offen offset:1024 sc1
    buffer_load_dwordx4 v[236:239], v58, s[12:15], s72 offen offset:2048 sc1
    buffer_load_dwordx4 v[240:243], v80, s[12:15], s72 offen offset:3072 sc1
    s_barrier
    ds_read_b64_tr_b16 a[224:225], v48 offset:0
    ds_read_b64_tr_b16 a[226:227], v48 offset:2048
    ds_read_b64_tr_b16 a[228:229], v49 offset:0
    ds_read_b64_tr_b16 a[230:231], v49 offset:2048
    ds_read_b64_tr_b16 a[232:233], v50 offset:0
    ds_read_b64_tr_b16 a[234:235], v50 offset:2048
    ds_read_b64_tr_b16 a[236:237], v51 offset:0
    ds_read_b64_tr_b16 a[238:239], v51 offset:2048
    ds_read_b64_tr_b16 a[240:241], v48 offset:4096
    ds_read_b64_tr_b16 a[242:243], v48 offset:6144
    ds_read_b64_tr_b16 a[244:245], v49 offset:4096
    ds_read_b64_tr_b16 a[246:247], v49 offset:6144
    s_waitcnt lgkmcnt(10)
    v_mfma_f32_16x16x32_bf16 v[16:19], a[224:227], v[84:87], 0
    s_add_u32 m0, s53, 16384
    ds_read_b64_tr_b16 a[248:249], v50 offset:4096
    s_add_u32 s47, s70, s71
    v_mfma_f32_16x16x32_bf16 v[32:35], a[224:227], v[88:91], 0
    s_waitcnt lgkmcnt(9)
    ds_read_b64_tr_b16 a[250:251], v50 offset:6144
    buffer_load_dwordx4 v68, s[16:19], s47 offen  lds
    v_mfma_f32_16x16x32_bf16 v[20:23], a[228:231], v[84:87], 0
    ds_read_b64_tr_b16 a[252:253], v51 offset:4096
    v_mfma_f32_16x16x32_bf16 v[36:39], a[228:231], v[88:91], 0
    s_waitcnt lgkmcnt(9)
    ds_read_b64_tr_b16 a[254:255], v51 offset:6144
    v_mfma_f32_16x16x32_bf16 v[24:27], a[232:235], v[84:87], 0
    s_add_u32 s71, s71, 256
    ds_read_b64_tr_b16 a[224:225], v48 offset:8192
    buffer_load_dwordx4 v69, s[16:19], s47 offen offset:1024  lds
    v_mfma_f32_16x16x32_bf16 v[40:43], a[232:235], v[88:91], 0
    s_waitcnt lgkmcnt(9)
    ds_read_b64_tr_b16 a[226:227], v48 offset:10240
    v_mfma_f32_16x16x32_bf16 v[28:31], a[236:239], v[84:87], 0
    ds_read_b64_tr_b16 a[228:229], v49 offset:8192
    v_mfma_f32_16x16x32_bf16 v[44:47], a[236:239], v[88:91], 0
    s_waitcnt lgkmcnt(9)
    ds_read_b64_tr_b16 a[230:231], v49 offset:10240
    s_and_b32 s71, s71, 2047
    v_mfma_f32_16x16x32_bf16 v[16:19], a[240:243], v[92:95], v[16:19]
    ds_read_b64_tr_b16 a[232:233], v50 offset:8192
    buffer_load_dwordx4 v70, s[16:19], s47 offen offset:2048  lds
    v_mfma_f32_16x16x32_bf16 v[32:35], a[240:243], v[96:99], v[32:35]
    s_waitcnt lgkmcnt(9)
    ds_read_b64_tr_b16 a[234:235], v50 offset:10240
    v_mfma_f32_16x16x32_bf16 v[20:23], a[244:247], v[92:95], v[20:23]
    ds_read_b64_tr_b16 a[236:237], v51 offset:8192
    v_mfma_f32_16x16x32_bf16 v[36:39], a[244:247], v[96:99], v[36:39]
    s_waitcnt lgkmcnt(9)
    ds_read_b64_tr_b16 a[238:239], v51 offset:10240
    buffer_load_dwordx4 v71, s[16:19], s47 offen offset:3072  lds
    v_mfma_f32_16x16x32_bf16 v[24:27], a[248:251], v[92:95], v[24:27]
    ds_read_b64_tr_b16 a[240:241], v48 offset:12288
    v_mfma_f32_16x16x32_bf16 v[40:43], a[248:251], v[96:99], v[40:43]
    s_waitcnt lgkmcnt(9)
    ds_read_b64_tr_b16 a[242:243], v48 offset:14336
    v_mfma_f32_16x16x32_bf16 v[28:31], a[252:255], v[92:95], v[28:31]
    s_mov_b32 m0, s53
    ds_read_b64_tr_b16 a[244:245], v49 offset:12288
    s_add_u32 s47, s70, s71
    v_mfma_f32_16x16x32_bf16 v[44:47], a[252:255], v[96:99], v[44:47]
    s_waitcnt lgkmcnt(9)
    ds_read_b64_tr_b16 a[246:247], v49 offset:14336
    buffer_load_dwordx4 v68, s[16:19], s47 offen  lds
    v_mfma_f32_16x16x32_bf16 v[16:19], a[224:227], v[100:103], v[16:19]
    ds_read_b64_tr_b16 a[248:249], v50 offset:12288
    v_mfma_f32_16x16x32_bf16 v[32:35], a[224:227], v[104:107], v[32:35]
    s_waitcnt lgkmcnt(9)
    ds_read_b64_tr_b16 a[250:251], v50 offset:14336
    v_mfma_f32_16x16x32_bf16 v[20:23], a[228:231], v[100:103], v[20:23]
    s_add_u32 s71, s71, 256
    ds_read_b64_tr_b16 a[252:253], v51 offset:12288
    buffer_load_dwordx4 v69, s[16:19], s47 offen offset:1024  lds
    v_mfma_f32_16x16x32_bf16 v[36:39], a[228:231], v[104:107], v[36:39]
    s_waitcnt lgkmcnt(9)
    ds_read_b64_tr_b16 a[254:255], v51 offset:14336
    s_waitcnt vmcnt(10)
    v_mfma_f32_16x16x32_bf16 v[24:27], a[232:235], v[100:103], v[24:27]
    s_barrier
    ds_read_b64_tr_b16 a[224:225], v48 offset:16384
    v_mfma_f32_16x16x32_bf16 v[40:43], a[232:235], v[104:107], v[40:43]
    s_waitcnt lgkmcnt(9)
    ds_read_b64_tr_b16 a[226:227], v48 offset:18432
    s_and_b32 s71, s71, 2047
    v_mfma_f32_16x16x32_bf16 v[28:31], a[236:239], v[100:103], v[28:31]
    ds_read_b64_tr_b16 a[228:229], v49 offset:16384
    buffer_load_dwordx4 v70, s[16:19], s47 offen offset:2048  lds
    v_mfma_f32_16x16x32_bf16 v[44:47], a[236:239], v[104:107], v[44:47]
    ds_read_b64_tr_b16 a[230:231], v49 offset:18432
    buffer_load_dwordx4 v71, s[16:19], s47 offen offset:3072  lds
    s_waitcnt vmcnt(8)
    v_xor_b32 v228, v228, v248
    v_xor_b32 v229, v229, v249
    v_xor_b32 v230, v230, v250
    v_xor_b32 v231, v231, v251
    v_xor_b32 v232, v232, v248
    v_xor_b32 v233, v233, v249
    v_xor_b32 v234, v234, v250
    v_xor_b32 v235, v235, v251
    v_xor_b32 v236, v236, v248
    v_xor_b32 v237, v237, v249
    v_xor_b32 v238, v238, v250
    v_xor_b32 v239, v239, v251
    s_mov_b32 exec_hi, 0
    v_xor_b32 v240, v240, v248
    v_xor_b32 v241, v241, v249
    v_xor_b32 v242, v242, v250
    v_xor_b32 v243, v243, v251
    s_mov_b32 exec_hi, -1
    v_or_b32 v1, v228, v229
    v_or3_b32 v1, v1, v230, v231
    v_or3_b32 v1, v1, v232, v233
    v_or3_b32 v1, v1, v234, v235
    v_or3_b32 v1, v1, v236, v237
    v_or3_b32 v1, v1, v238, v239
    v_or3_b32 v1, v1, v240, v241
    v_or3_b32 v1, v1, v242, v243
    v_and_b32 v1, 15, v1
    v_cmp_ne_u32 vcc, 0, v1
    s_nop 4
    s_cbranch_vccnz L_slow_1
L_back_2:
    v_pk_add_f32 v[228:229], v[228:229], v[232:233]
    v_pk_add_f32 v[230:231], v[230:231], v[234:235]
    v_pk_add_f32 v[236:237], v[236:237], v[240:241]
    v_pk_add_f32 v[238:239], v[238:239], v[242:243]
    v_pk_add_f32 v[228:229], v[228:229], v[236:237]
    v_pk_add_f32 v[230:231], v[230:231], v[238:239]
    s_mov_b32 vcc_lo, 0x0000ffff
    s_mov_b32 vcc_hi, 0x0000ffff
    v_permlane32_swap_b32 v228, v230
    v_permlane32_swap_b32 v229, v231
    v_pk_add_f32 v[232:233], v[228:229], v[230:231]
    v_pk_add_f32 v[228:229], v[228:229], v[230:231]
    s_nop 1
    v_permlane16_swap_b32 v228, v232
    v_permlane16_swap_b32 v229, v233
    v_add_f32 v228, v228, v232
    v_add_f32 v230, v229, v233
    v_mul_f32 v228, 0x3a924925, v228
    v_mul_f32 v230, 0x3a924925, v230
    v_fma_f32 v230, -v228, v228, v230
    v_max_f32 v230, 0, v230
    v_add_f32 v230, 0x3727c5ac, v230
    v_rsq_f32 v230, v230
    s_nop 0
    v_mul_f32 v228, v228, v230
    v_cndmask_b32 v228, v228, v230, vcc
    ds_write_b32 v252, v228
    ds_read_b128 v[232:235], v253 offset:0
    ds_read_b128 v[236:239], v253 offset:128
    ds_read_b128 v[240:243], v253 offset:16
    ds_read_b128 v[244:247], v253 offset:144
    s_waitcnt lgkmcnt(0)
    v_pk_fma_f32 v[196:197], v[196:197], v[232:233], v[236:237] neg_lo:[0,0,1] neg_hi:[0,0,1]
    v_pk_fma_f32 v[198:199], v[198:199], v[234:235], v[238:239] neg_lo:[0,0,1] neg_hi:[0,0,1]
    v_pk_fma_f32 v[212:213], v[212:213], v[240:241], v[244:245] neg_lo:[0,0,1] neg_hi:[0,0,1]
    v_pk_fma_f32 v[214:215], v[214:215], v[242:243], v[246:247] neg_lo:[0,0,1] neg_hi:[0,0,1]
    v_cvt_pk_bf16_f32 v196, v196, v197
    v_cvt_pk_bf16_f32 v197, v198, v199
    v_cvt_pk_bf16_f32 v198, v212, v213
    v_cvt_pk_bf16_f32 v199, v214, v215
    buffer_store_dwordx4 v[196:199], v58, s[12:15], s73 offen sc1
    v_pk_fma_f32 v[200:201], v[200:201], v[232:233], v[236:237] neg_lo:[0,0,1] neg_hi:[0,0,1]
    v_pk_fma_f32 v[202:203], v[202:203], v[234:235], v[238:239] neg_lo:[0,0,1] neg_hi:[0,0,1]
    v_pk_fma_f32 v[216:217], v[216:217], v[240:241], v[244:245] neg_lo:[0,0,1] neg_hi:[0,0,1]
    v_pk_fma_f32 v[218:219], v[218:219], v[242:243], v[246:247] neg_lo:[0,0,1] neg_hi:[0,0,1]
    v_cvt_pk_bf16_f32 v200, v200, v201
    v_cvt_pk_bf16_f32 v201, v202, v203
    v_cvt_pk_bf16_f32 v202, v216, v217
    v_cvt_pk_bf16_f32 v203, v218, v219
    s_add_u32 s73, s73, 65536
    buffer_store_dwordx4 v[200:203], v58, s[12:15], s73 offen sc1
    v_pk_fma_f32 v[204:205], v[204:205], v[232:233], v[236:237] neg_lo:[0,0,1] neg_hi:[0,0,1]
    v_pk_fma_f32 v[206:207], v[206:207], v[234:235], v[238:239] neg_lo:[0,0,1] neg_hi:[0,0,1]
    v_pk_fma_f32 v[220:221], v[220:221], v[240:241], v[244:245] neg_lo:[0,0,1] neg_hi:[0,0,1]
    v_pk_fma_f32 v[222:223], v[222:223], v[242:243], v[246:247] neg_lo:[0,0,1] neg_hi:[0,0,1]
    v_cvt_pk_bf16_f32 v204, v204, v205
    v_cvt_pk_bf16_f32 v205, v206, v207
    v_cvt_pk_bf16_f32 v206, v220, v221
    v_cvt_pk_bf16_f32 v207, v222, v223
    s_add_u32 s73, s73, 65536
    buffer_store_dwordx4 v[204:207], v58, s[12:15], s73 offen sc1
    v_pk_fma_f32 v[208:209], v[208:209], v[232:233], v[236:237] neg_lo:[0,0,1] neg_hi:[0,0,1]
    v_pk_fma_f32 v[210:211], v[210:211], v[234:235], v[238:239] neg_lo:[0,0,1] neg_hi:[0,0,1]
    v_pk_fma_f32 v[224:225], v[224:225], v[240:241], v[244:245] neg_lo:[0,0,1] neg_hi:[0,0,1]
    v_pk_fma_f32 v[226:227], v[226:227], v[242:243], v[246:247] neg_lo:[0,0,1] neg_hi:[0,0,1]
    v_cvt_pk_bf16_f32 v208, v208, v209
    v_cvt_pk_bf16_f32 v209, v210, v211
    v_cvt_pk_bf16_f32 v210, v224, v225
    v_cvt_pk_bf16_f32 v211, v226, v227
    s_add_u32 s73, s73, 65536
    buffer_store_dwordx4 v[208:211], v58, s[12:15], s73 offen sc1
    v_mfma_f32_16x16x32_bf16 v[16:19], a[240:243], v[108:111], v[16:19]
    s_add_u32 m0, s53, 4096
    ds_read_b64_tr_b16 a[232:233], v50 offset:16384
    s_add_u32 s47, s70, s71
    v_mfma_f32_16x16x32_bf16 v[32:35], a[240:243], v[112:115], v[32:35]
    ds_read_b64_tr_b16 a[234:235], v50 offset:18432
    buffer_load_dwordx4 v68, s[16:19], s47 offen  lds
    v_mfma_f32_16x16x32_bf16 v[20:23], a[244:247], v[108:111], v[20:23]
    s_lshl_b32 s45, s37, 12
    ds_read_b64_tr_b16 a[236:237], v51 offset:16384
    s_mul_i32 s46, s38, 2176
    v_mfma_f32_16x16x32_bf16 v[36:39], a[244:247], v[112:115], v[36:39]
    ds_read_b64_tr_b16 a[238:239], v51 offset:18432
    s_add_u32 s87, s45, s46
    v_mfma_f32_16x16x32_bf16 v[24:27], a[248:251], v[108:111], v[24:27]
    s_xor_b32 s86, s87, 128
    ds_read_b64_tr_b16 a[240:241], v48 offset:20480
    v_lshlrev_b32 v80, 8, v63
    v_mfma_f32_16x16x32_bf16 v[40:43], a[248:251], v[112:115], v[40:43]
    ds_read_b64_tr_b16 a[242:243], v48 offset:22528
    s_add_u32 s71, s71, 1408
    v_mfma_f32_16x16x32_bf16 v[28:31], a[252:255], v[108:111], v[28:31]
    s_lshl_b32 s45, s38, 15
    ds_read_b64_tr_b16 a[244:245], v49 offset:20480
    buffer_load_dwordx4 v69, s[16:19], s47 offen offset:1024  lds
    v_mfma_f32_16x16x32_bf16 v[44:47], a[252:255], v[112:115], v[44:47]
    ds_read_b64_tr_b16 a[246:247], v49 offset:22528
    s_add_u32 s45, s45, 7340032
    v_mfma_f32_16x16x32_bf16 v[16:19], a[224:227], v[116:119], v[16:19]
    s_xor_b32 s46, s40, 1
    ds_read_b64_tr_b16 a[248:249], v50 offset:20480
    s_lshl2_add_u32 s46, s46, s36
    v_mfma_f32_16x16x32_bf16 v[32:35], a[224:227], v[120:123], v[32:35]
    ds_read_b64_tr_b16 a[250:251], v50 offset:22528
    s_lshl_b32 s46, s46, 16
    v_mfma_f32_16x16x32_bf16 v[20:23], a[228:231], v[116:119], v[20:23]
    s_and_b32 s71, s71, 2047
    ds_read_b64_tr_b16 a[252:253], v51 offset:20480
    buffer_load_dwordx4 v70, s[16:19], s47 offen offset:2048  lds
    v_mfma_f32_16x16x32_bf16 v[36:39], a[228:231], v[120:123], v[36:39]
    s_waitcnt lgkmcnt(9)
    ds_read_b64_tr_b16 a[254:255], v51 offset:22528
    s_add_u32 s77, s45, s46
    v_mfma_f32_16x16x32_bf16 v[24:27], a[232:235], v[116:119], v[24:27]
    s_lshr_b32 s46, s36, 1
    ds_read_b64_tr_b16 a[224:225], v48 offset:24576
    s_lshl2_add_u32 s46, s40, s46
    v_mfma_f32_16x16x32_bf16 v[40:43], a[232:235], v[120:123], v[40:43]
    s_waitcnt lgkmcnt(9)
    ds_read_b64_tr_b16 a[226:227], v48 offset:26624
    s_lshl_b32 s46, s46, 16
    v_mfma_f32_16x16x32_bf16 v[28:31], a[236:239], v[116:119], v[28:31]
    s_add_u32 s45, s45, s46
    ds_read_b64_tr_b16 a[228:229], v49 offset:24576
    buffer_load_dwordx4 v71, s[16:19], s47 offen offset:3072  lds
    v_mfma_f32_16x16x32_bf16 v[44:47], a[236:239], v[120:123], v[44:47]
    s_waitcnt lgkmcnt(9)
    ds_read_b64_tr_b16 a[230:231], v49 offset:26624
    s_and_b32 s46, s36, 1
    v_mfma_f32_16x16x32_bf16 v[16:19], a[240:243], v[124:127], v[16:19]
    s_lshl_b32 s46, s46, 11
    ds_read_b64_tr_b16 a[232:233], v50 offset:24576
    s_add_u32 s78, s45, s46
    v_mfma_f32_16x16x32_bf16 v[32:35], a[240:243], v[128:131], v[32:35]
    s_waitcnt lgkmcnt(9)
    ds_read_b64_tr_b16 a[234:235], v50 offset:26624
    s_mul_i32 s81, s37, 4096
    v_mfma_f32_16x16x32_bf16 v[20:23], a[244:247], v[124:127], v[20:23]
    s_add_u32 m0, s53, 12288
    ds_read_b64_tr_b16 a[236:237], v51 offset:24576
    s_add_u32 s47, s70, s71
    v_mfma_f32_16x16x32_bf16 v[36:39], a[244:247], v[128:131], v[36:39]
    s_waitcnt lgkmcnt(9)
    ds_read_b64_tr_b16 a[238:239], v51 offset:26624
    buffer_load_dwordx4 v68, s[16:19], s47 offen  lds
    v_mfma_f32_16x16x32_bf16 v[24:27], a[248:251], v[124:127], v[24:27]
    s_lshl_b32 s89, s36, 11
    ds_read_b64_tr_b16 a[240:241], v48 offset:28672
    v_mfma_f32_16x16x32_bf16 v[40:43], a[248:251], v[128:131], v[40:43]
    s_waitcnt lgkmcnt(9)
    ds_read_b64_tr_b16 a[242:243], v48 offset:30720
    v_mfma_f32_16x16x32_bf16 v[28:31], a[252:255], v[124:127], v[28:31]
    ds_read_b64_tr_b16 a[244:245], v49 offset:28672
    v_mfma_f32_16x16x32_bf16 v[44:47], a[252:255], v[128:131], v[44:47]
    s_waitcnt lgkmcnt(9)
    ds_read_b64_tr_b16 a[246:247], v49 offset:30720
    s_add_u32 s71, s71, 256
    v_mfma_f32_16x16x32_bf16 v[16:19], a[224:227], v[132:135], v[16:19]
    ds_read_b64_tr_b16 a[248:249], v50 offset:28672
    buffer_load_dwordx4 v69, s[16:19], s47 offen offset:1024  lds
    v_mfma_f32_16x16x32_bf16 v[32:35], a[224:227], v[136:139], v[32:35]
    s_waitcnt lgkmcnt(9)
    ds_read_b64_tr_b16 a[250:251], v50 offset:30720
    v_mfma_f32_16x16x32_bf16 v[20:23], a[228:231], v[132:135], v[20:23]
    ds_read_b64_tr_b16 a[252:253], v51 offset:28672
    v_mfma_f32_16x16x32_bf16 v[36:39], a[228:231], v[136:139], v[36:39]
    s_waitcnt lgkmcnt(9)
    ds_read_b64_tr_b16 a[254:255], v51 offset:30720
    v_mfma_f32_16x16x32_bf16 v[24:27], a[232:235], v[132:135], v[24:27]
    s_and_b32 s71, s71, 2047
    ds_read_b64_tr_b16 a[224:225], v48 offset:32768
    buffer_load_dwordx4 v70, s[16:19], s47 offen offset:2048  lds
    v_mfma_f32_16x16x32_bf16 v[40:43], a[232:235], v[136:139], v[40:43]
    s_waitcnt lgkmcnt(9)
    ds_read_b64_tr_b16 a[226:227], v48 offset:34816
    v_mfma_f32_16x16x32_bf16 v[28:31], a[236:239], v[132:135], v[28:31]
    ds_read_b64_tr_b16 a[228:229], v49 offset:32768
    v_mfma_f32_16x16x32_bf16 v[44:47], a[236:239], v[136:139], v[44:47]
    s_waitcnt lgkmcnt(9)
    ds_read_b64_tr_b16 a[230:231], v49 offset:34816
    v_mfma_f32_16x16x32_bf16 v[16:19], a[240:243], v[140:143], v[16:19]
    ds_read_b64_tr_b16 a[232:233], v50 offset:32768
    buffer_load_dwordx4 v71, s[16:19], s47 offen offset:3072  lds
    v_mfma_f32_16x16x32_bf16 v[32:35], a[240:243], v[144:147], v[32:35]
    s_waitcnt lgkmcnt(9)
    ds_read_b64_tr_b16 a[234:235], v50 offset:34816
    v_mfma_f32_16x16x32_bf16 v[20:23], a[244:247], v[140:143], v[20:23]
    ds_read_b64_tr_b16 a[236:237], v51 offset:32768
    v_mfma_f32_16x16x32_bf16 v[36:39], a[244:247], v[144:147], v[36:39]
    s_waitcnt lgkmcnt(9)
    ds_read_b64_tr_b16 a[238:239], v51 offset:34816
    v_mfma_f32_16x16x32_bf16 v[24:27], a[248:251], v[140:143], v[24:27]
    s_add_u32 m0, s53, 20480
    ds_read_b64_tr_b16 a[240:241], v48 offset:36864
    s_add_u32 s47, s70, s71
    v_mfma_f32_16x16x32_bf16 v[40:43], a[248:251], v[144:147], v[40:43]
    s_waitcnt lgkmcnt(9)
    ds_read_b64_tr_b16 a[242:243], v48 offset:38912
    buffer_load_dwordx4 v68, s[16:19], s47 offen  lds
    v_mfma_f32_16x16x32_bf16 v[28:31], a[252:255], v[140:143], v[28:31]
    ds_read_b64_tr_b16 a[244:245], v49 offset:36864
    v_mfma_f32_16x16x32_bf16 v[44:47], a[252:255], v[144:147], v[44:47]
    s_waitcnt lgkmcnt(9)
    ds_read_b64_tr_b16 a[246:247], v49 offset:38912
    v_mfma_f32_16x16x32_bf16 v[16:19], a[224:227], v[148:151], v[16:19]
    ds_read_b64_tr_b16 a[248:249], v50 offset:36864
    v_mfma_f32_16x16x32_bf16 v[32:35], a[224:227], v[152:155], v[32:35]
    s_waitcnt lgkmcnt(9)
    ds_read_b64_tr_b16 a[250:251], v50 offset:38912
    s_add_u32 s71, s71, 256
    v_mfma_f32_16x16x32_bf16 v[20:23], a[228:231], v[148:151], v[20:23]
    s_waitcnt vmcnt(9)
    ds_read_b64_tr_b16 a[252:253], v51 offset:36864
    buffer_load_dwordx4 v69, s[16:19], s47 offen offset:1024  lds
    v_mfma_f32_16x16x32_bf16 v[36:39], a[228:231], v[152:155], v[36:39]
    s_waitcnt lgkmcnt(9)
    ds_read_b64_tr_b16 a[254:255], v51 offset:38912
    s_barrier
    v_mfma_f32_16x16x32_bf16 v[24:27], a[232:235], v[148:151], v[24:27]
    s_mov_b32 s52, 65536
    buffer_store_dwordx4 v[4:7], v59, s[12:15], s52 offen sc1
    v_mfma_f32_16x16x32_bf16 v[40:43], a[232:235], v[152:155], v[40:43]
    s_waitcnt lgkmcnt(8)
    ds_read_b64_tr_b16 a[224:225], v48 offset:40960
    ds_read_b64_tr_b16 a[226:227], v48 offset:43008
    v_mfma_f32_16x16x32_bf16 v[28:31], a[236:239], v[148:151], v[28:31]
    s_and_b32 s71, s71, 2047
    ds_read_b64_tr_b16 a[228:229], v49 offset:40960
    buffer_load_dwordx4 v70, s[16:19], s47 offen offset:2048  lds
    v_mfma_f32_16x16x32_bf16 v[44:47], a[236:239], v[152:155], v[44:47]
    s_waitcnt lgkmcnt(9)
    ds_read_b64_tr_b16 a[230:231], v49 offset:43008
    v_mfma_f32_16x16x32_bf16 v[16:19], a[240:243], v[156:159], v[16:19]
    ds_read_b64_tr_b16 a[232:233], v50 offset:40960
    v_mfma_f32_16x16x32_bf16 v[32:35], a[240:243], v[160:163], v[32:35]
    s_waitcnt lgkmcnt(9)
    ds_read_b64_tr_b16 a[234:235], v50 offset:43008
    v_mfma_f32_16x16x32_bf16 v[20:23], a[244:247], v[156:159], v[20:23]
    ds_read_b64_tr_b16 a[236:237], v51 offset:40960
    buffer_load_dwordx4 v71, s[16:19], s47 offen offset:3072  lds
    v_mfma_f32_16x16x32_bf16 v[36:39], a[244:247], v[160:163], v[36:39]
    s_waitcnt lgkmcnt(9)
    ds_read_b64_tr_b16 a[238:239], v51 offset:43008
    v_mfma_f32_16x16x32_bf16 v[24:27], a[248:251], v[156:159], v[24:27]
    ds_read_b64_tr_b16 a[240:241], v48 offset:45056
    v_mfma_f32_16x16x32_bf16 v[40:43], a[248:251], v[160:163], v[40:43]
    s_waitcnt lgkmcnt(9)
    ds_read_b64_tr_b16 a[242:243], v48 offset:47104
    v_mfma_f32_16x16x32_bf16 v[28:31], a[252:255], v[156:159], v[28:31]
    ds_read_b64_tr_b16 a[244:245], v49 offset:45056
    s_add_u32 m0, s53, 8192
    v_mfma_f32_16x16x32_bf16 v[44:47], a[252:255], v[160:163], v[44:47]
    s_waitcnt lgkmcnt(9)
    ds_read_b64_tr_b16 a[246:247], v49 offset:47104
    s_add_u32 s47, s70, s71
    v_mfma_f32_16x16x32_bf16 v[16:19], a[224:227], v[164:167], v[16:19]
    ds_read_b64_tr_b16 a[248:249], v50 offset:45056
    buffer_load_dwordx4 v68, s[16:19], s47 offen  lds
    v_mfma_f32_16x16x32_bf16 v[32:35], a[224:227], v[168:171], v[32:35]
    s_waitcnt lgkmcnt(9)
    ds_read_b64_tr_b16 a[250:251], v50 offset:47104
    v_mfma_f32_16x16x32_bf16 v[20:23], a[228:231], v[164:167], v[20:23]
    ds_read_b64_tr_b16 a[252:253], v51 offset:45056
    v_mfma_f32_16x16x32_bf16 v[36:39], a[228:231], v[168:171], v[36:39]
    s_waitcnt lgkmcnt(9)
    ds_read_b64_tr_b16 a[254:255], v51 offset:47104
    v_mfma_f32_16x16x32_bf16 v[24:27], a[232:235], v[164:167], v[24:27]
    s_add_u32 s71, s71, 256
    ds_read_b64_tr_b16 a[224:225], v48 offset:49152
    buffer_load_dwordx4 v69, s[16:19], s47 offen offset:1024  lds
    v_mfma_f32_16x16x32_bf16 v[40:43], a[232:235], v[168:171], v[40:43]
    s_waitcnt lgkmcnt(9)
    ds_read_b64_tr_b16 a[226:227], v48 offset:51200
    v_mfma_f32_16x16x32_bf16 v[28:31], a[236:239], v[164:167], v[28:31]
    ds_read_b64_tr_b16 a[228:229], v49 offset:49152
    v_mfma_f32_16x16x32_bf16 v[44:47], a[236:239], v[168:171], v[44:47]
    s_waitcnt lgkmcnt(9)
    ds_read_b64_tr_b16 a[230:231], v49 offset:51200
    v_mfma_f32_16x16x32_bf16 v[16:19], a[240:243], v[172:175], v[16:19]
    s_and_b32 s71, s71, 2047
    ds_read_b64_tr_b16 a[232:233], v50 offset:49152
    buffer_load_dwordx4 v70, s[16:19], s47 offen offset:2048  lds
    v_mfma_f32_16x16x32_bf16 v[32:35], a[240:243], v[176:179], v[32:35]
    s_waitcnt lgkmcnt(9)
    ds_read_b64_tr_b16 a[234:235], v50 offset:51200
    v_mfma_f32_16x16x32_bf16 v[20:23], a[244:247], v[172:175], v[20:23]
    ds_read_b64_tr_b16 a[236:237], v51 offset:49152
    v_mfma_f32_16x16x32_bf16 v[36:39], a[244:247], v[176:179], v[36:39]
    s_waitcnt lgkmcnt(9)
    ds_read_b64_tr_b16 a[238:239], v51 offset:51200
    v_mfma_f32_16x16x32_bf16 v[24:27], a[248:251], v[172:175], v[24:27]
    ds_read_b64_tr_b16 a[240:241], v48 offset:53248
    buffer_load_dwordx4 v71, s[16:19], s47 offen offset:3072  lds
    v_mfma_f32_16x16x32_bf16 v[40:43], a[248:251], v[176:179], v[40:43]
    s_waitcnt lgkmcnt(9)
    ds_read_b64_tr_b16 a[242:243], v48 offset:55296
    v_mfma_f32_16x16x32_bf16 v[28:31], a[252:255], v[172:175], v[28:31]
    ds_read_b64_tr_b16 a[244:245], v49 offset:53248
    v_mfma_f32_16x16x32_bf16 v[44:47], a[252:255], v[176:179], v[44:47]
    s_waitcnt lgkmcnt(9)
    ds_read_b64_tr_b16 a[246:247], v49 offset:55296
    v_mfma_f32_16x16x32_bf16 v[16:19], a[224:227], v[180:183], v[16:19]
    ds_read_b64_tr_b16 a[248:249], v50 offset:53248
    ds_read_b128 a[32:35], v76 offset:16384
    v_mfma_f32_16x16x32_bf16 v[32:35], a[224:227], v[184:187], v[32:35]
    s_waitcnt lgkmcnt(10)
    ds_read_b64_tr_b16 a[250:251], v50 offset:55296
    ds_read_b128 a[36:39], v76 offset:18432
    v_mfma_f32_16x16x32_bf16 v[20:23], a[228:231], v[180:183], v[20:23]
    ds_read_b64_tr_b16 a[252:253], v51 offset:53248
    ds_read_b128 a[40:43], v77 offset:16384
    v_mfma_f32_16x16x32_bf16 v[36:39], a[228:231], v[184:187], v[36:39]
    s_waitcnt lgkmcnt(12)
    ds_read_b64_tr_b16 a[254:255], v51 offset:55296
    ds_read_b128 a[44:47], v77 offset:18432
    v_mfma_f32_16x16x32_bf16 v[24:27], a[232:235], v[180:183], v[24:27]
    ds_read_b128 a[64:67], v76 offset:0
    v_mfma_f32_16x16x32_bf16 v[40:43], a[232:235], v[184:187], v[40:43]
    s_waitcnt lgkmcnt(13)
    ds_read_b128 a[68:71], v76 offset:2048
    v_mfma_f32_16x16x32_bf16 v[28:31], a[236:239], v[180:183], v[28:31]
    ds_read_b128 a[72:75], v77 offset:0
    v_mfma_f32_16x16x32_bf16 v[44:47], a[236:239], v[184:187], v[44:47]
    s_waitcnt lgkmcnt(13)
    ds_read_b128 a[76:79], v77 offset:2048
    v_mfma_f32_16x16x32_bf16 v[16:19], a[240:243], v[188:191], v[16:19]
    s_waitcnt vmcnt(13)
    ds_read_b128 a[96:99], v76 offset:4096
    v_mfma_f32_16x16x32_bf16 v[32:35], a[240:243], v[192:195], v[32:35]
    s_waitcnt lgkmcnt(13)
    ds_read_b128 a[100:103], v76 offset:6144
    v_mfma_f32_16x16x32_bf16 v[20:23], a[244:247], v[188:191], v[20:23]
    ds_read_b128 a[104:107], v77 offset:4096
    v_mfma_f32_16x16x32_bf16 v[36:39], a[244:247], v[192:195], v[36:39]
    s_waitcnt lgkmcnt(12)
    ds_read_b128 a[108:111], v77 offset:6144
    v_mfma_f32_16x16x32_bf16 v[24:27], a[248:251], v[188:191], v[24:27]
    s_waitcnt lgkmcnt(8)
    s_add_u32 m0, s53, 16384
    s_add_u32 s47, s70, s71
    v_mfma_f32_16x16x32_bf16 v[40:43], a[248:251], v[192:195], v[40:43]
    buffer_load_dwordx4 v68, s[16:19], s47 offen  lds
    v_mfma_f32_16x16x32_bf16 v[28:31], a[252:255], v[188:191], v[28:31]
    v_mfma_f32_16x16x32_bf16 v[44:47], a[252:255], v[192:195], v[44:47]
    s_add_u32 s71, s71, 128
    buffer_load_dwordx4 v69, s[16:19], s47 offen offset:1024  lds
    s_and_b32 s71, s71, 2047
    buffer_load_dwordx4 v70, s[16:19], s47 offen offset:2048  lds
    buffer_load_dwordx4 v71, s[16:19], s47 offen offset:3072  lds
    s_waitcnt vmcnt(13)
    ds_read_b128 a[16:19], v76 offset:12288
L_pad2:
    s_cbranch_execz L_pad6
    ds_read_b128 a[20:23], v76 offset:14336
    ds_read_b128 a[24:27], v77 offset:12288
    ds_read_b128 a[28:31], v77 offset:14336
    v_pk_mul_f32 v[244:245], v[16:17], v[16:17]
    v_pk_mul_f32 v[246:247], v[18:19], v[18:19]
    v_pk_mul_f32 v[248:249], v[20:21], v[20:21]
    v_pk_mul_f32 v[250:251], v[22:23], v[22:23]
    v_pk_fma_f32 v[244:245], v[244:245], s[50:51], v[78:79]
    v_pk_fma_f32 v[246:247], v[246:247], s[50:51], v[78:79]
    v_pk_fma_f32 v[248:249], v[248:249], s[50:51], v[78:79]
    v_pk_fma_f32 v[250:251], v[250:251], s[50:51], v[78:79]
    v_pk_mul_f32 v[244:245], v[244:245], v[16:17]
    v_pk_mul_f32 v[246:247], v[246:247], v[18:19]
    s_waitcnt lgkmcnt(8)
    s_mov_b32 m0, s53
    s_add_u32 s47, s70, s71
    buffer_load_dwordx4 v68, s[16:19], s47 offen  lds
    s_add_u32 s71, s71, 128
    buffer_load_dwordx4 v69, s[16:19], s47 offen offset:1024  lds
    s_and_b32 s71, s71, 2047
    buffer_load_dwordx4 v70, s[16:19], s47 offen offset:2048  lds
    buffer_load_dwordx4 v71, s[16:19], s47 offen offset:3072  lds
    v_pk_mul_f32 v[248:249], v[248:249], v[20:21]
    v_pk_mul_f32 v[250:251], v[250:251], v[22:23]
    v_exp_f32 v244, v244
    v_exp_f32 v245, v245
    v_exp_f32 v246, v246
    v_exp_f32 v247, v247
    v_exp_f32 v248, v248
    v_exp_f32 v249, v249
    v_exp_f32 v250, v250
    v_exp_f32 v251, v251
    s_waitcnt vmcnt(12)
    ds_read_b128 a[48:51], v76 offset:20480
    ds_read_b128 a[52:55], v76 offset:22528
    ds_read_b128 a[56:59], v77 offset:20480
    ds_read_b128 a[60:63], v77 offset:22528
    v_pk_add_f32 v[244:245], v[244:245], 1.0 op_sel_hi:[1,0]
    v_pk_add_f32 v[246:247], v[246:247], 1.0 op_sel_hi:[1,0]
    v_pk_add_f32 v[248:249], v[248:249], 1.0 op_sel_hi:[1,0]
    v_pk_add_f32 v[250:251], v[250:251], 1.0 op_sel_hi:[1,0]
    v_rcp_f32 v244, v244
    v_rcp_f32 v245, v245
    v_rcp_f32 v246, v246
    v_rcp_f32 v247, v247
    v_rcp_f32 v248, v248
    v_rcp_f32 v249, v249
    s_add_u32 s52, s86, 65536
    buffer_load_dword v61, v80, s[12:15], s52 offen sc1
    v_rcp_f32 v250, v250
    v_rcp_f32 v251, v251
    v_pk_mul_f32 v[16:17], v[244:245], v[16:17]
    v_pk_mul_f32 v[18:19], v[246:247], v[18:19]
    v_pk_mul_f32 v[20:21], v[248:249], v[20:21]
    v_pk_mul_f32 v[22:23], v[250:251], v[22:23]
    v_pk_mul_f32 v[244:245], v[24:25], v[24:25]
    v_pk_mul_f32 v[246:247], v[26:27], v[26:27]
    v_pk_mul_f32 v[248:249], v[28:29], v[28:29]
    v_pk_mul_f32 v[250:251], v[30:31], v[30:31]
    v_pk_fma_f32 v[244:245], v[244:245], s[50:51], v[78:79]
    s_waitcnt lgkmcnt(8)
    s_add_u32 m0, s53, 4096
    s_add_u32 s47, s70, s71
    buffer_load_dwordx4 v68, s[16:19], s47 offen  lds
    s_add_u32 s71, s71, 128
    buffer_load_dwordx4 v69, s[16:19], s47 offen offset:1024  lds
    s_and_b32 s71, s71, 2047
    buffer_load_dwordx4 v70, s[16:19], s47 offen offset:2048  lds
    buffer_load_dwordx4 v71, s[16:19], s47 offen offset:3072  lds
    v_pk_fma_f32 v[246:247], v[246:247], s[50:51], v[78:79]
    v_pk_fma_f32 v[248:249], v[248:249], s[50:51], v[78:79]
    v_pk_fma_f32 v[250:251], v[250:251], s[50:51], v[78:79]
    v_pk_mul_f32 v[244:245], v[244:245], v[24:25]
    v_pk_mul_f32 v[246:247], v[246:247], v[26:27]
    v_pk_mul_f32 v[248:249], v[248:249], v[28:29]
    v_pk_mul_f32 v[250:251], v[250:251], v[30:31]
    v_exp_f32 v244, v244
    v_exp_f32 v245, v245
    v_exp_f32 v246, v246
    s_waitcnt vmcnt(13)
    ds_read_b128 a[80:83], v76 offset:8192
    ds_read_b128 a[84:87], v76 offset:10240
    ds_read_b128 a[88:91], v77 offset:8192
    ds_read_b128 a[92:95], v77 offset:10240
    v_exp_f32 v247, v247
    v_exp_f32 v248, v248
    v_exp_f32 v249, v249
    v_exp_f32 v250, v250
    v_exp_f32 v251, v251
    v_pk_add_f32 v[244:245], v[244:245], 1.0 op_sel_hi:[1,0]
    v_pk_add_f32 v[246:247], v[246:247], 1.0 op_sel_hi:[1,0]
    v_pk_add_f32 v[248:249], v[248:249], 1.0 op_sel_hi:[1,0]
    v_pk_add_f32 v[250:251], v[250:251], 1.0 op_sel_hi:[1,0]
    v_rcp_f32 v244, v244
    s_waitcnt lgkmcnt(8)
    s_add_u32 m0, s53, 12288
    s_add_u32 s47, s70, s71
    buffer_load_dwordx4 v68, s[16:19], s47 offen  lds
    s_add_u32 s71, s71, 128
    buffer_load_dwordx4 v69, s[16:19], s47 offen offset:1024  lds
    s_and_b32 s71, s71, 2047
    buffer_load_dwordx4 v70, s[16:19], s47 offen offset:2048  lds
    buffer_load_dwordx4 v71, s[16:19], s47 offen offset:3072  lds
    v_rcp_f32 v245, v245
    v_rcp_f32 v246, v246
    v_rcp_f32 v247, v247
    v_rcp_f32 v248, v248
    v_rcp_f32 v249, v249
    v_rcp_f32 v250, v250
    v_rcp_f32 v251, v251
    v_pk_mul_f32 v[24:25], v[244:245], v[24:25]
    v_pk_mul_f32 v[26:27], v[246:247], v[26:27]
    v_pk_mul_f32 v[28:29], v[248:249], v[28:29]
    v_pk_mul_f32 v[30:31], v[250:251], v[30:31]
    s_barrier
    v_add_u32 v66, 131072, v58
    s_waitcnt vmcnt(8)
    v_cmp_ne_u32 vcc, s43, v61
    s_nop 4
    s_cbranch_vccnz L_slow_3
L_back_4:
    s_mov_b32 m0, s89
    s_add_u32 s82, s77, s81
    buffer_load_dwordx4 v58, s[12:15], s82 offen sc1 lds
    s_add_u32 s81, s81, 2048
    buffer_load_dwordx4 v58, s[12:15], s82 offen offset:1024 sc1 lds
    s_and_b32 s81, s81, 0x7fff
    s_add_u32 m0, s89, 8192
    s_add_u32 s82, s77, s81
    buffer_load_dwordx4 v58, s[12:15], s82 offen sc1 lds
    s_add_u32 s81, s81, 2048
    buffer_load_dwordx4 v58, s[12:15], s82 offen offset:1024 sc1 lds
    s_and_b32 s81, s81, 0x7fff
    v_pk_mul_f32 v[244:245], v[32:33], v[32:33]
    v_pk_mul_f32 v[246:247], v[34:35], v[34:35]
    v_pk_mul_f32 v[248:249], v[36:37], v[36:37]
    v_pk_mul_f32 v[250:251], v[38:39], v[38:39]
    v_pk_fma_f32 v[244:245], v[244:245], s[50:51], v[78:79]
    v_pk_fma_f32 v[246:247], v[246:247], s[50:51], v[78:79]
    v_pk_fma_f32 v[248:249], v[248:249], s[50:51], v[78:79]
    v_pk_fma_f32 v[250:251], v[250:251], s[50:51], v[78:79]
    v_pk_mul_f32 v[244:245], v[244:245], v[32:33]
    v_pk_mul_f32 v[246:247], v[246:247], v[34:35]
    v_pk_mul_f32 v[248:249], v[248:249], v[36:37]
    v_pk_mul_f32 v[250:251], v[250:251], v[38:39]
    s_add_u32 m0, s89, 16384
    s_add_u32 s82, s77, s81
    buffer_load_dwordx4 v58, s[12:15], s82 offen sc1 lds
    s_add_u32 s81, s81, 2048
    buffer_load_dwordx4 v58, s[12:15], s82 offen offset:1024 sc1 lds
    s_and_b32 s81, s81, 0x7fff
    v_exp_f32 v244, v244
    v_exp_f32 v245, v245
    v_exp_f32 v246, v246
    v_exp_f32 v247, v247
    v_exp_f32 v248, v248
    v_exp_f32 v249, v249
    v_exp_f32 v250, v250
    v_exp_f32 v251, v251
    v_pk_add_f32 v[244:245], v[244:245], 1.0 op_sel_hi:[1,0]
    v_pk_add_f32 v[246:247], v[246:247], 1.0 op_sel_hi:[1,0]
    v_pk_add_f32 v[248:249], v[248:249], 1.0 op_sel_hi:[1,0]
    v_pk_add_f32 v[250:251], v[250:251], 1.0 op_sel_hi:[1,0]
    ds_read_b128 a[112:115], v76 offset:16384
    ds_read_b128 a[116:119], v76 offset:18432
    ds_read_b128 a[120:123], v77 offset:16384
    ds_read_b128 a[124:127], v77 offset:18432
    v_rcp_f32 v244, v244
    v_rcp_f32 v245, v245
    v_rcp_f32 v246, v246
    v_rcp_f32 v247, v247
    v_rcp_f32 v248, v248
    v_rcp_f32 v249, v249
    v_rcp_f32 v250, v250
    v_rcp_f32 v251, v251
    v_pk_mul_f32 v[32:33], v[244:245], v[32:33]
    v_pk_mul_f32 v[34:35], v[246:247], v[34:35]
    v_pk_mul_f32 v[36:37], v[248:249], v[36:37]
    v_pk_mul_f32 v[38:39], v[250:251], v[38:39]
    s_add_u32 m0, s89, 24576
    s_add_u32 s82, s77, s81
    buffer_load_dwordx4 v58, s[12:15], s82 offen sc1 lds
    s_add_u32 s81, s81, 2048
    buffer_load_dwordx4 v58, s[12:15], s82 offen offset:1024 sc1 lds
    s_and_b32 s81, s81, 0x7fff
    v_pk_mul_f32 v[244:245], v[40:41], v[40:41]
    v_pk_mul_f32 v[246:247], v[42:43], v[42:43]
    v_pk_mul_f32 v[248:249], v[44:45], v[44:45]
    v_pk_mul_f32 v[250:251], v[46:47], v[46:47]
    v_pk_fma_f32 v[244:245], v[244:245], s[50:51], v[78:79]
    v_pk_fma_f32 v[246:247], v[246:247], s[50:51], v[78:79]
    v_pk_fma_f32 v[248:249], v[248:249], s[50:51], v[78:79]
    v_pk_fma_f32 v[250:251], v[250:251], s[50:51], v[78:79]
    v_pk_mul_f32 v[244:245], v[244:245], v[40:41]
    v_pk_mul_f32 v[246:247], v[246:247], v[42:43]
    v_pk_mul_f32 v[248:249], v[248:249], v[44:45]
    v_pk_mul_f32 v[250:251], v[250:251], v[46:47]
    ds_read_b128 a[128:131], v76 offset:0
    ds_read_b128 a[132:135], v76 offset:2048
    ds_read_b128 a[136:139], v77 offset:0
    ds_read_b128 a[140:143], v77 offset:2048
    v_exp_f32 v244, v244
    v_exp_f32 v245, v245
    v_exp_f32 v246, v246
    v_exp_f32 v247, v247
    v_exp_f32 v248, v248
    v_exp_f32 v249, v249
    v_exp_f32 v250, v250
    v_exp_f32 v251, v251
    v_pk_add_f32 v[244:245], v[244:245], 1.0 op_sel_hi:[1,0]
    v_pk_add_f32 v[246:247], v[246:247], 1.0 op_sel_hi:[1,0]
    v_pk_add_f32 v[248:249], v[248:249], 1.0 op_sel_hi:[1,0]
    v_pk_add_f32 v[250:251], v[250:251], 1.0 op_sel_hi:[1,0]
    s_add_u32 m0, s89, 32768
    s_add_u32 s82, s77, s81
    buffer_load_dwordx4 v58, s[12:15], s82 offen sc1 lds
    s_add_u32 s81, s81, 2048
    buffer_load_dwordx4 v58, s[12:15], s82 offen offset:1024 sc1 lds
    s_and_b32 s81, s81, 0x7fff
    v_rcp_f32 v244, v244
    v_rcp_f32 v245, v245
    v_rcp_f32 v246, v246
    v_rcp_f32 v247, v247
    v_rcp_f32 v248, v248
    v_rcp_f32 v249, v249
    v_rcp_f32 v250, v250
    v_rcp_f32 v251, v251
    v_pk_mul_f32 v[40:41], v[244:245], v[40:41]
    v_pk_mul_f32 v[42:43], v[246:247], v[42:43]
    v_pk_mul_f32 v[44:45], v[248:249], v[44:45]
    v_pk_mul_f32 v[46:47], v[250:251], v[46:47]
    s_waitcnt vmcnt(6)
    s_barrier
    ds_read_b128 v[212:215], v58 offset:0
    ds_read_b128 v[216:219], v58 offset:1024
    ds_read_b128 v[220:223], v58 offset:2048
    ds_read_b128 v[224:227], v58 offset:3072
    ds_read_b128 v[228:231], v58 offset:4096
    s_waitcnt lgkmcnt(3)
    v_mfma_f32_16x16x32_bf16 v[84:87], v[212:215], a[0:3], 0
    s_add_u32 m0, s89, 40960
    ds_read_b128 v[232:235], v58 offset:5120
    s_add_u32 s82, s77, s81
    v_mfma_f32_16x16x32_bf16 v[84:87], v[216:219], a[8:11], v[84:87]
    buffer_load_dwordx4 v58, s[12:15], s82 offen sc1 lds
    v_mfma_f32_16x16x32_bf16 v[88:91], v[216:219], a[12:15], 0
    s_add_u32 s81, s81, 2048
    ds_read_b128 v[236:239], v58 offset:6144
    s_lshl2_add_u32 s45, s39, s36
    v_mfma_f32_16x16x32_bf16 v[88:91], v[212:215], a[4:7], v[88:91]
    s_waitcnt lgkmcnt(3)
    buffer_load_dwordx4 v58, s[12:15], s82 offen offset:1024 sc1 lds
    v_mfma_f32_16x16x32_bf16 v[92:95], v[220:223], a[0:3], 0
    s_and_b32 s81, s81, 0x7fff
    ds_read_b128 v[240:243], v58 offset:7168
    s_add_u32 m0, s89, 49152
    v_mfma_f32_16x16x32_bf16 v[92:95], v[224:227], a[8:11], v[92:95]
    s_add_u32 s82, s77, s81
    buffer_load_dwordx4 v58, s[12:15], s82 offen sc1 lds
    v_mfma_f32_16x16x32_bf16 v[96:99], v[224:227], a[12:15], 0
    s_add_u32 s81, s81, 2048
    ds_read_b128 v[212:215], v58 offset:8192
    s_mul_i32 s45, s45, 57344
    v_mfma_f32_16x16x32_bf16 v[96:99], v[220:223], a[4:7], v[96:99]
    s_waitcnt lgkmcnt(3)
    buffer_load_dwordx4 v58, s[12:15], s82 offen offset:1024 sc1 lds
    v_mfma_f32_16x16x32_bf16 v[100:103], v[228:231], a[0:3], 0
    s_and_b32 s81, s81, 0x7fff
    ds_read_b128 v[216:219], v58 offset:9216
    v_mfma_f32_16x16x32_bf16 v[100:103], v[232:235], a[8:11], v[100:103]
    s_add_u32 m0, s53, 20480
    ds_read_b128 a[144:147], v76 offset:4096
    s_add_u32 s47, s70, s71
    v_mfma_f32_16x16x32_bf16 v[104:107], v[232:235], a[12:15], 0
    s_lshl_b32 s46, s40, 11
    ds_read_b128 v[220:223], v58 offset:10240
    s_add_u32 s45, s45, s46
    v_mfma_f32_16x16x32_bf16 v[104:107], v[228:231], a[4:7], v[104:107]
    s_waitcnt lgkmcnt(4)
    buffer_load_dwordx4 v68, s[16:19], s47 offen  lds
    v_mfma_f32_16x16x32_bf16 v[108:111], v[236:239], a[0:3], 0
    s_add_u32 s79, s45, 11534336
    ds_read_b128 v[224:227], v58 offset:11264
    s_mul_i32 s45, s37, 114688
    v_mfma_f32_16x16x32_bf16 v[108:111], v[240:243], a[8:11], v[108:111]
    s_add_u32 s45, s45, 24117248
    ds_read_b128 a[148:151], v76 offset:6144
    v_add_u32 v65, s45, v58
    v_mfma_f32_16x16x32_bf16 v[112:115], v[240:243], a[12:15], 0
    s_add_u32 s71, s71, 128
    ds_read_b128 v[228:231], v58 offset:12288
    s_and_b32 s45, s37, 1
    v_mfma_f32_16x16x32_bf16 v[112:115], v[236:239], a[4:7], v[112:115]
    s_waitcnt lgkmcnt(5)
    buffer_load_dwordx4 v69, s[16:19], s47 offen offset:1024  lds
    v_mfma_f32_16x16x32_bf16 v[84:87], v[212:215], a[16:19], v[84:87]
    s_mul_i32 s88, s45, 14
    ds_read_b128 v[232:235], v58 offset:13312
    s_add_u32 s84, s88, s36
    v_mfma_f32_16x16x32_bf16 v[84:87], v[216:219], a[24:27], v[84:87]
    s_lshl_b32 s85, s36, 12
    ds_read_b128 a[152:155], v77 offset:4096
    v_mov_b32 v64, 0
    v_mfma_f32_16x16x32_bf16 v[88:91], v[216:219], a[28:31], v[88:91]
    s_and_b32 s71, s71, 2047
    ds_read_b128 v[236:239], v58 offset:14336
    v_and_b32 v1, 3, v0
    v_mfma_f32_16x16x32_bf16 v[88:91], v[212:215], a[20:23], v[88:91]
    s_waitcnt lgkmcnt(5)
    buffer_load_dwordx4 v70, s[16:19], s47 offen offset:2048  lds
    v_mfma_f32_16x16x32_bf16 v[92:95], v[220:223], a[16:19], v[92:95]
    ds_read_b128 v[240:243], v58 offset:15360
    v_lshlrev_b32 v1, 3, v1
    v_mfma_f32_16x16x32_bf16 v[92:95], v[224:227], a[24:27], v[92:95]
    ds_read_b128 a[156:159], v77 offset:6144
    v_mfma_f32_16x16x32_bf16 v[96:99], v[224:227], a[28:31], v[96:99]
    s_waitcnt vmcnt(9)
    buffer_load_dwordx4 v71, s[16:19], s47 offen offset:3072  lds
    v_mfma_f32_16x16x32_bf16 v[96:99], v[220:223], a[20:23], v[96:99]
    s_waitcnt lgkmcnt(4)
    ds_read_b128 a[160:163], v76 offset:12288
    s_barrier
    v_mfma_f32_16x16x32_bf16 v[100:103], v[228:231], a[16:19], v[100:103]
    ds_read_b128 v[212:215], v58 offset:16384
    v_lshrrev_b32 v1, v1, v4
    v_mfma_f32_16x16x32_bf16 v[100:103], v[232:235], a[24:27], v[100:103]
    s_add_u32 m0, s89, 155648
    ds_read_b128 v[216:219], v58 offset:17408
    s_add_u32 s82, s77, s81
    v_mfma_f32_16x16x32_bf16 v[104:107], v[232:235], a[28:31], v[104:107]
    ds_read_b128 v[220:223], v58 offset:18432
    v_and_b32 v1, 0xff, v1
    v_mfma_f32_16x16x32_bf16 v[104:107], v[228:231], a[20:23], v[104:107]
    s_waitcnt lgkmcnt(5)
    buffer_load_dwordx4 v58, s[12:15], s82 offen sc1 lds
    v_mfma_f32_16x16x32_bf16 v[108:111], v[236:239], a[16:19], v[108:111]
    s_add_u32 s81, s81, 2048
    ds_read_b128 v[224:227], v58 offset:19456
    v_lshl_or_b32 v1, v1, 12, v1
    v_mfma_f32_16x16x32_bf16 v[108:111], v[240:243], a[24:27], v[108:111]
    s_mov_b32 s54, 0xfffefffe
    buffer_load_dwordx4 v58, s[12:15], s82 offen offset:1024 sc1 lds
    v_mfma_f32_16x16x32_bf16 v[112:115], v[240:243], a[28:31], v[112:115]
    s_and_b32 s81, s81, 0x7fff
    ds_read_b128 v[228:231], v58 offset:20480
    s_mov_b32 m0, s89
    v_mfma_f32_16x16x32_bf16 v[112:115], v[236:239], a[20:23], v[112:115]
    s_waitcnt lgkmcnt(3)
    ds_read_b128 a[164:167], v76 offset:14336
    s_add_u32 s82, s77, s81
    v_mfma_f32_16x16x32_bf16 v[84:87], v[212:215], a[32:35], v[84:87]
    s_mov_b32 s55, 0xffff0000
    ds_read_b128 v[232:235], v58 offset:21504
    v_mov_b32 v79, 0x8000
    v_mfma_f32_16x16x32_bf16 v[84:87], v[216:219], a[40:43], v[84:87]
    buffer_load_dwordx4 v58, s[12:15], s82 offen sc1 lds
    v_mfma_f32_16x16x32_bf16 v[88:91], v[216:219], a[44:47], v[88:91]
    s_add_u32 s81, s81, 2048
    ds_read_b128 v[236:239], v58 offset:22528
    v_lshrrev_b32 v72, 0, v1
    v_mfma_f32_16x16x32_bf16 v[88:91], v[212:215], a[36:39], v[88:91]
    s_waitcnt lgkmcnt(4)
    buffer_load_dwordx4 v58, s[12:15], s82 offen offset:1024 sc1 lds
    v_mfma_f32_16x16x32_bf16 v[92:95], v[220:223], a[32:35], v[92:95]
    s_and_b32 s81, s81, 0x7fff
    ds_read_b128 v[240:243], v58 offset:23552
    v_mfma_f32_16x16x32_bf16 v[92:95], v[224:227], a[40:43], v[92:95]
    s_add_u32 m0, s53, 8192
    ds_read_b128 a[168:171], v77 offset:12288
    s_add_u32 s47, s70, s71
    v_mfma_f32_16x16x32_bf16 v[96:99], v[224:227], a[44:47], v[96:99]
    ds_read_b128 v[212:215], v58 offset:24576
    v_and_b32 v72, 0x00010001, v72
    v_mfma_f32_16x16x32_bf16 v[96:99], v[220:223], a[36:39], v[96:99]
    s_waitcnt lgkmcnt(4)
    buffer_load_dwordx4 v68, s[16:19], s47 offen  lds
    v_mfma_f32_16x16x32_bf16 v[100:103], v[228:231], a[32:35], v[100:103]
    ds_read_b128 v[216:219], v58 offset:25600
    v_lshrrev_b32 v73, 1, v1
    v_mfma_f32_16x16x32_bf16 v[100:103], v[232:235], a[40:43], v[100:103]
    ds_read_b128 a[172:175], v77 offset:14336
    v_and_b32 v73, 0x00010001, v73
    v_mfma_f32_16x16x32_bf16 v[104:107], v[232:235], a[44:47], v[104:107]
    s_add_u32 s71, s71, 128
    ds_read_b128 v[220:223], v58 offset:26624
    v_lshrrev_b32 v74, 2, v1
    v_mfma_f32_16x16x32_bf16 v[104:107], v[228:231], a[36:39], v[104:107]
    s_waitcnt lgkmcnt(5)
    buffer_load_dwordx4 v69, s[16:19], s47 offen offset:1024  lds
    v_mfma_f32_16x16x32_bf16 v[108:111], v[236:239], a[32:35], v[108:111]
    ds_read_b128 v[224:227], v58 offset:27648
    v_and_b32 v74, 0x00010001, v74
    v_mfma_f32_16x16x32_bf16 v[108:111], v[240:243], a[40:43], v[108:111]
    v_lshrrev_b32 v75, 3, v1
    v_and_b32 v75, 0x00010001, v75
    v_mfma_f32_16x16x32_bf16 v[112:115], v[240:243], a[44:47], v[112:115]
    s_and_b32 s71, s71, 2047
    ds_read_b128 v[228:231], v58 offset:28672
    v_lshlrev_b32 v48, 16, v56
    v_mfma_f32_16x16x32_bf16 v[112:115], v[236:239], a[36:39], v[112:115]
    s_waitcnt lgkmcnt(4)
    buffer_load_dwordx4 v70, s[16:19], s47 offen offset:2048  lds
    v_mfma_f32_16x16x32_bf16 v[84:87], v[212:215], a[48:51], v[84:87]
    ds_read_b128 v[232:235], v58 offset:29696
    v_lshlrev_b32 v49, 16, v56
    v_mfma_f32_16x16x32_bf16 v[84:87], v[216:219], a[56:59], v[84:87]
    v_lshlrev_b32 v50, 16, v56
    v_lshlrev_b32 v51, 16, v56
    v_mfma_f32_16x16x32_bf16 v[88:91], v[216:219], a[60:63], v[88:91]
    ds_read_b128 v[236:239], v58 offset:30720
    v_lshlrev_b32 v52, 16, v57
    v_mfma_f32_16x16x32_bf16 v[88:91], v[212:215], a[52:55], v[88:91]
    s_waitcnt lgkmcnt(3)
    buffer_load_dwordx4 v71, s[16:19], s47 offen offset:3072  lds
    v_mfma_f32_16x16x32_bf16 v[92:95], v[220:223], a[48:51], v[92:95]
    ds_read_b128 v[240:243], v58 offset:31744
    v_lshlrev_b32 v53, 16, v57
    v_mfma_f32_16x16x32_bf16 v[92:95], v[224:227], a[56:59], v[92:95]
    v_lshlrev_b32 v54, 16, v57
    v_lshlrev_b32 v55, 16, v57
    v_mfma_f32_16x16x32_bf16 v[96:99], v[224:227], a[60:63], v[96:99]
    s_waitcnt vmcnt(14)
    s_barrier
    ds_read_b128 v[212:215], v58 offset:32768
    v_mfma_f32_16x16x32_bf16 v[96:99], v[220:223], a[52:55], v[96:99]
    s_waitcnt lgkmcnt(3)
    s_add_u32 m0, s89, 8192
    s_add_u32 s82, s77, s81
    v_mfma_f32_16x16x32_bf16 v[100:103], v[228:231], a[48:51], v[100:103]
    s_waitcnt vmcnt(8)
    ds_read_b128 v[216:219], v58 offset:33792
    s_lshl_b32 s87, s37, 12
    v_mfma_f32_16x16x32_bf16 v[100:103], v[232:235], a[56:59], v[100:103]
    s_lshl_b32 s45, s36, 10
    buffer_load_dwordx4 v58, s[12:15], s82 offen sc1 lds
    v_mfma_f32_16x16x32_bf16 v[104:107], v[232:235], a[60:63], v[104:107]
    s_add_u32 s81, s81, 2048
    ds_read_b128 v[220:223], v58 offset:34816
    v_lshl_add_u32 v80, v63, 7, s45
    v_mfma_f32_16x16x32_bf16 v[104:107], v[228:231], a[52:55], v[104:107]
    s_waitcnt lgkmcnt(3)
    buffer_load_dwordx4 v58, s[12:15], s82 offen offset:1024 sc1 lds
    v_mfma_f32_16x16x32_bf16 v[108:111], v[236:239], a[48:51], v[108:111]
    s_and_b32 s81, s81, 0x7fff
    ds_read_b128 v[224:227], v58 offset:35840
    v_mfma_f32_16x16x32_bf16 v[108:111], v[240:243], a[56:59], v[108:111]
    s_add_u32 m0, s53, 16384
    ds_read_b128 a[176:179], v76 offset:20480
    s_add_u32 s47, s70, s71
    v_mfma_f32_16x16x32_bf16 v[112:115], v[240:243], a[60:63], v[112:115]
    s_add_u32 s52, s87, 65536
    ds_read_b128 v[228:231], v58 offset:36864
    v_mfma_f32_16x16x32_bf16 v[112:115], v[236:239], a[52:55], v[112:115]
    s_waitcnt lgkmcnt(4)
    buffer_load_dwordx4 v68, s[16:19], s47 offen  lds
    v_mfma_f32_16x16x32_bf16 v[84:87], v[212:215], a[64:67], v[84:87]
    ds_read_b128 v[232:235], v58 offset:37888
    v_mfma_f32_16x16x32_bf16 v[84:87], v[216:219], a[72:75], v[84:87]
    ds_read_b128 a[180:183], v76 offset:22528
    v_mfma_f32_16x16x32_bf16 v[88:91], v[216:219], a[76:79], v[88:91]
    s_add_u32 s71, s71, 128
    ds_read_b128 v[236:239], v58 offset:38912
    v_mfma_f32_16x16x32_bf16 v[88:91], v[212:215], a[68:71], v[88:91]
    s_waitcnt lgkmcnt(5)
    buffer_load_dwordx4 v69, s[16:19], s47 offen offset:1024  lds
    v_mfma_f32_16x16x32_bf16 v[92:95], v[220:223], a[64:67], v[92:95]
    ds_read_b128 v[240:243], v58 offset:39936
    v_mfma_f32_16x16x32_bf16 v[92:95], v[224:227], a[72:75], v[92:95]
    ds_read_b128 a[184:187], v77 offset:20480
    v_mfma_f32_16x16x32_bf16 v[96:99], v[224:227], a[76:79], v[96:99]
    s_and_b32 s71, s71, 2047
    ds_read_b128 v[212:215], v58 offset:40960
    v_mfma_f32_16x16x32_bf16 v[96:99], v[220:223], a[68:71], v[96:99]
    s_waitcnt lgkmcnt(5)
    buffer_load_dwordx4 v70, s[16:19], s47 offen offset:2048  lds
    v_mfma_f32_16x16x32_bf16 v[100:103], v[228:231], a[64:67], v[100:103]
    ds_read_b128 v[216:219], v58 offset:41984
    v_mfma_f32_16x16x32_bf16 v[100:103], v[232:235], a[72:75], v[100:103]
    ds_read_b128 a[188:191], v77 offset:22528
    v_mfma_f32_16x16x32_bf16 v[104:107], v[232:235], a[76:79], v[104:107]
    ds_read_b128 v[220:223], v58 offset:43008
    v_mfma_f32_16x16x32_bf16 v[104:107], v[228:231], a[68:71], v[104:107]
    s_waitcnt lgkmcnt(5)
    buffer_load_dwordx4 v71, s[16:19], s47 offen offset:3072  lds
    v_mfma_f32_16x16x32_bf16 v[108:111], v[236:239], a[64:67], v[108:111]
    ds_read_b128 v[224:227], v58 offset:44032
    v_mfma_f32_16x16x32_bf16 v[108:111], v[240:243], a[72:75], v[108:111]
    buffer_load_dword v61, v80, s[12:15], s52 offen sc1
    v_mfma_f32_16x16x32_bf16 v[112:115], v[240:243], a[76:79], v[112:115]
    s_add_u32 m0, s89, 16384
    ds_read_b128 v[228:231], v58 offset:45056
    s_add_u32 s82, s77, s81
    v_mfma_f32_16x16x32_bf16 v[112:115], v[236:239], a[68:71], v[112:115]
    s_waitcnt lgkmcnt(4)
    buffer_load_dwordx4 v58, s[12:15], s82 offen sc1 lds
    v_mfma_f32_16x16x32_bf16 v[84:87], v[212:215], a[80:83], v[84:87]
    s_add_u32 s81, s81, 2048
    ds_read_b128 v[232:235], v58 offset:46080
    v_mfma_f32_16x16x32_bf16 v[84:87], v[216:219], a[88:91], v[84:87]
    buffer_load_dwordx4 v58, s[12:15], s82 offen offset:1024 sc1 lds
    v_mfma_f32_16x16x32_bf16 v[88:91], v[216:219], a[92:95], v[88:91]
    s_and_b32 s81, s81, 0x7fff
    ds_read_b128 v[236:239], v58 offset:47104
    v_mfma_f32_16x16x32_bf16 v[88:91], v[212:215], a[84:87], v[88:91]
    s_waitcnt lgkmcnt(3)
    v_mfma_f32_16x16x32_bf16 v[92:95], v[220:223], a[80:83], v[92:95]
    ds_read_b128 v[240:243], v58 offset:48128
    v_mfma_f32_16x16x32_bf16 v[92:95], v[224:227], a[88:91], v[92:95]
    v_mfma_f32_16x16x32_bf16 v[96:99], v[224:227], a[92:95], v[96:99]
    s_waitcnt vmcnt(15)
    s_barrier
    ds_read_b128 v[212:215], v58 offset:49152
    v_mfma_f32_16x16x32_bf16 v[96:99], v[220:223], a[84:87], v[96:99]
    s_waitcnt lgkmcnt(3)
    s_add_u32 m0, s89, 24576
    s_add_u32 s82, s77, s81
    v_mfma_f32_16x16x32_bf16 v[100:103], v[228:231], a[80:83], v[100:103]
    s_waitcnt vmcnt(9)
    ds_read_b128 v[216:219], v58 offset:50176
    v_mfma_f32_16x16x32_bf16 v[100:103], v[232:235], a[88:91], v[100:103]
    buffer_load_dwordx4 v58, s[12:15], s82 offen sc1 lds
    v_mfma_f32_16x16x32_bf16 v[104:107], v[232:235], a[92:95], v[104:107]
    s_add_u32 s81, s81, 2048
    ds_read_b128 v[220:223], v58 offset:51200
    v_mfma_f32_16x16x32_bf16 v[104:107], v[228:231], a[84:87], v[104:107]
    s_waitcnt lgkmcnt(3)
    buffer_load_dwordx4 v58, s[12:15], s82 offen offset:1024 sc1 lds
    v_mfma_f32_16x16x32_bf16 v[108:111], v[236:239], a[80:83], v[108:111]
    s_and_b32 s81, s81, 0x7fff
    ds_read_b128 v[224:227], v58 offset:52224
    v_mfma_f32_16x16x32_bf16 v[108:111], v[240:243], a[88:91], v[108:111]
    s_mov_b32 m0, s53
    ds_read_b128 a[192:195], v76 offset:8192
    s_add_u32 s47, s70, s71
    v_mfma_f32_16x16x32_bf16 v[112:115], v[240:243], a[92:95], v[112:115]
    ds_read_b128 v[228:231], v58 offset:53248
    v_mfma_f32_16x16x32_bf16 v[112:115], v[236:239], a[84:87], v[112:115]
    s_waitcnt lgkmcnt(4)
    buffer_load_dwordx4 v68, s[16:19], s47 offen  lds
    v_mfma_f32_16x16x32_bf16 v[84:87], v[212:215], a[96:99], v[84:87]
    ds_read_b128 v[232:235], v58 offset:54272
    v_mfma_f32_16x16x32_bf16 v[84:87], v[216:219], a[104:107], v[84:87]
    ds_read_b128 a[196:199], v76 offset:10240
    v_mfma_f32_16x16x32_bf16 v[88:91], v[216:219], a[108:111], v[88:91]
    s_add_u32 s71, s71, 128
    ds_read_b128 v[236:239], v58 offset:55296
    v_mfma_f32_16x16x32_bf16 v[88:91], v[212:215], a[100:103], v[88:91]
    s_waitcnt lgkmcnt(5)
    buffer_load_dwordx4 v69, s[16:19], s47 offen offset:1024  lds
    v_mfma_f32_16x16x32_bf16 v[92:95], v[220:223], a[96:99], v[92:95]
    ds_read_b128 v[240:243], v58 offset:56320
    v_mfma_f32_16x16x32_bf16 v[92:95], v[224:227], a[104:107], v[92:95]
    ds_read_b128 a[200:203], v77 offset:8192
    v_mfma_f32_16x16x32_bf16 v[96:99], v[224:227], a[108:111], v[96:99]
    s_and_b32 s71, s71, 2047
    ds_read_b128 v[212:215], v66 offset:24576
    v_mfma_f32_16x16x32_bf16 v[96:99], v[220:223], a[100:103], v[96:99]
    s_waitcnt lgkmcnt(5)
    buffer_load_dwordx4 v70, s[16:19], s47 offen offset:2048  lds
    v_mfma_f32_16x16x32_bf16 v[100:103], v[228:231], a[96:99], v[100:103]
    ds_read_b128 v[216:219], v66 offset:25600
    v_mfma_f32_16x16x32_bf16 v[100:103], v[232:235], a[104:107], v[100:103]
    ds_read_b128 a[204:207], v77 offset:10240
    v_mfma_f32_16x16x32_bf16 v[104:107], v[232:235], a[108:111], v[104:107]
    ds_read_b128 v[220:223], v66 offset:26624
    v_mfma_f32_16x16x32_bf16 v[104:107], v[228:231], a[100:103], v[104:107]
    s_waitcnt lgkmcnt(5)
    buffer_load_dwordx4 v71, s[16:19], s47 offen offset:3072  lds
    v_mfma_f32_16x16x32_bf16 v[108:111], v[236:239], a[96:99], v[108:111]
    ds_read_b128 v[224:227], v66 offset:27648
    v_mfma_f32_16x16x32_bf16 v[108:111], v[240:243], a[104:107], v[108:111]
    v_mfma_f32_16x16x32_bf16 v[112:115], v[240:243], a[108:111], v[112:115]
    s_add_u32 m0, s89, 32768
    ds_read_b128 v[228:231], v66 offset:28672
    s_add_u32 s82, s77, s81
    v_mfma_f32_16x16x32_bf16 v[112:115], v[236:239], a[100:103], v[112:115]
    s_waitcnt lgkmcnt(4)
    buffer_load_dwordx4 v58, s[12:15], s82 offen sc1 lds
    v_mfma_f32_16x16x32_bf16 v[84:87], v[212:215], a[112:115], v[84:87]
    s_add_u32 s81, s81, 2048
    ds_read_b128 v[232:235], v66 offset:29696
    v_mfma_f32_16x16x32_bf16 v[84:87], v[216:219], a[120:123], v[84:87]
    buffer_load_dwordx4 v58, s[12:15], s82 offen offset:1024 sc1 lds
    v_mfma_f32_16x16x32_bf16 v[88:91], v[216:219], a[124:127], v[88:91]
    s_and_b32 s81, s81, 0x7fff
    ds_read_b128 v[236:239], v66 offset:30720
    v_mfma_f32_16x16x32_bf16 v[88:91], v[212:215], a[116:119], v[88:91]
    s_waitcnt lgkmcnt(3)
    v_mfma_f32_16x16x32_bf16 v[92:95], v[220:223], a[112:115], v[92:95]
    ds_read_b128 v[240:243], v66 offset:31744
    v_mfma_f32_16x16x32_bf16 v[92:95], v[224:227], a[120:123], v[92:95]
    v_mfma_f32_16x16x32_bf16 v[96:99], v[224:227], a[124:127], v[96:99]
    s_waitcnt vmcnt(15)
    s_barrier
    ds_read_b128 v[212:215], v58 offset:0
L_pad3:
    s_cbranch_execz L_warm
    v_mfma_f32_16x16x32_bf16 v[96:99], v[220:223], a[116:119], v[96:99]
    s_waitcnt lgkmcnt(3)
    s_add_u32 m0, s89, 40960
    s_add_u32 s82, s77, s81
    v_mfma_f32_16x16x32_bf16 v[100:103], v[228:231], a[112:115], v[100:103]
    s_waitcnt vmcnt(11)
    ds_read_b128 v[216:219], v58 offset:1024
    v_mfma_f32_16x16x32_bf16 v[100:103], v[232:235], a[120:123], v[100:103]
    buffer_load_dwordx4 v58, s[12:15], s82 offen sc1 lds
    v_mfma_f32_16x16x32_bf16 v[104:107], v[232:235], a[124:127], v[104:107]
    s_add_u32 s81, s81, 2048
    ds_read_b128 v[220:223], v58 offset:2048
    v_mfma_f32_16x16x32_bf16 v[104:107], v[228:231], a[116:119], v[104:107]
    s_waitcnt lgkmcnt(3)
    buffer_load_dwordx4 v58, s[12:15], s82 offen offset:1024 sc1 lds
    v_mfma_f32_16x16x32_bf16 v[108:111], v[236:239], a[112:115], v[108:111]
    s_and_b32 s81, s81, 0x7fff
    ds_read_b128 v[224:227], v58 offset:3072
    v_mfma_f32_16x16x32_bf16 v[108:111], v[240:243], a[120:123], v[108:111]
    s_add_u32 m0, s53, 4096
    ds_read_b128 a[208:211], v76 offset:16384
    s_add_u32 s47, s70, s71
    v_mfma_f32_16x16x32_bf16 v[112:115], v[240:243], a[124:127], v[112:115]
    ds_read_b128 v[228:231], v58 offset:4096
    v_mfma_f32_16x16x32_bf16 v[112:115], v[236:239], a[116:119], v[112:115]
    s_waitcnt lgkmcnt(4)
    buffer_load_dwordx4 v68, s[16:19], s47 offen  lds
    v_mfma_f32_16x16x32_bf16 v[84:87], v[212:215], a[128:131], v[84:87]
    ds_read_b128 v[232:235], v58 offset:5120
    v_mfma_f32_16x16x32_bf16 v[84:87], v[216:219], a[136:139], v[84:87]
    ds_read_b128 a[212:215], v76 offset:18432
    v_mfma_f32_16x16x32_bf16 v[88:91], v[216:219], a[140:143], v[88:91]
    s_add_u32 s71, s71, 128
    ds_read_b128 v[236:239], v58 offset:6144
    v_mfma_f32_16x16x32_bf16 v[88:91], v[212:215], a[132:135], v[88:91]
    s_waitcnt lgkmcnt(5)
    buffer_load_dwordx4 v69, s[16:19], s47 offen offset:1024  lds
    v_mfma_f32_16x16x32_bf16 v[92:95], v[220:223], a[128:131], v[92:95]
    ds_read_b128 v[240:243], v58 offset:7168
    v_mfma_f32_16x16x32_bf16 v[92:95], v[224:227], a[136:139], v[92:95]
    ds_read_b128 a[216:219], v77 offset:16384
    v_mfma_f32_16x16x32_bf16 v[96:99], v[224:227], a[140:143], v[96:99]
    s_and_b32 s71, s71, 2047
    ds_read_b128 v[212:215], v58 offset:8192
    v_mfma_f32_16x16x32_bf16 v[96:99], v[220:223], a[132:135], v[96:99]
    s_waitcnt lgkmcnt(5)
    buffer_load_dwordx4 v70, s[16:19], s47 offen offset:2048  lds
    v_mfma_f32_16x16x32_bf16 v[100:103], v[228:231], a[128:131], v[100:103]
    ds_read_b128 v[216:219], v58 offset:9216
    v_mfma_f32_16x16x32_bf16 v[100:103], v[232:235], a[136:139], v[100:103]
    ds_read_b128 a[220:223], v77 offset:18432
    v_mfma_f32_16x16x32_bf16 v[104:107], v[232:235], a[140:143], v[104:107]
    ds_read_b128 v[220:223], v58 offset:10240
    v_mfma_f32_16x16x32_bf16 v[104:107], v[228:231], a[132:135], v[104:107]
    s_waitcnt lgkmcnt(5)
    buffer_load_dwordx4 v71, s[16:19], s47 offen offset:3072  lds
    v_mfma_f32_16x16x32_bf16 v[108:111], v[236:239], a[128:131], v[108:111]
    s_waitcnt vmcnt(16)
    ds_read_b128 v[224:227], v58 offset:11264
    v_cmp_ne_u32 vcc, s43, v61
    v_mfma_f32_16x16x32_bf16 v[108:111], v[240:243], a[136:139], v[108:111]
    v_mfma_f32_16x16x32_bf16 v[112:115], v[240:243], a[140:143], v[112:115]
    s_add_u32 m0, s89, 49152
    ds_read_b128 v[228:231], v58 offset:12288
    s_add_u32 s82, s77, s81
    v_mfma_f32_16x16x32_bf16 v[112:115], v[236:239], a[132:135], v[112:115]
    s_waitcnt lgkmcnt(4)
    buffer_load_dwordx4 v58, s[12:15], s82 offen sc1 lds
    v_mfma_f32_16x16x32_bf16 v[84:87], v[212:215], a[144:147], v[84:87]
    s_add_u32 s81, s81, 2048
    ds_read_b128 v[232:235], v58 offset:13312
    s_cbranch_vccnz L_slow_5
L_back_6:
    v_mfma_f32_16x16x32_bf16 v[84:87], v[216:219], a[152:155], v[84:87]
    s_lshr_b32 s45, s36, 1
    buffer_load_dwordx4 v58, s[12:15], s82 offen offset:1024 sc1 lds
    v_mfma_f32_16x16x32_bf16 v[88:91], v[216:219], a[156:159], v[88:91]
    s_and_b32 s81, s81, 0x7fff
    ds_read_b128 v[236:239], v58 offset:14336
    s_mul_i32 s45, s45, 4096
    v_mfma_f32_16x16x32_bf16 v[88:91], v[212:215], a[148:151], v[88:91]
    s_waitcnt lgkmcnt(3)
    s_lshl_b32 s46, s36, 8
    s_add_u32 s45, s45, s46
    v_mfma_f32_16x16x32_bf16 v[92:95], v[220:223], a[144:147], v[92:95]
    s_add_u32 s45, s45, 131808
    ds_read_b128 v[240:243], v58 offset:15360
    v_and_b32 v1, 15, v0
    v_mfma_f32_16x16x32_bf16 v[92:95], v[224:227], a[152:155], v[92:95]
    v_and_b32 v2, 48, v0
    v_lshlrev_b32 v3, 5, v1
    v_mfma_f32_16x16x32_bf16 v[96:99], v[224:227], a[156:159], v[96:99]
    s_waitcnt vmcnt(14)
    s_barrier
    ds_read_b128 v[212:215], v58 offset:16384
    v_mfma_f32_16x16x32_bf16 v[96:99], v[220:223], a[148:151], v[96:99]
    s_waitcnt lgkmcnt(3)
    s_mov_b32 m0, s89
    s_add_u32 s82, s77, s81
    v_mfma_f32_16x16x32_bf16 v[100:103], v[228:231], a[144:147], v[100:103]
    s_waitcnt vmcnt(10)
    ds_read_b128 v[216:219], v58 offset:17408
    v_sub_u32 v3, s45, v3
    v_mfma_f32_16x16x32_bf16 v[100:103], v[232:235], a[152:155], v[100:103]
    buffer_load_dwordx4 v58, s[12:15], s82 offen sc1 lds
    v_mfma_f32_16x16x32_bf16 v[104:107], v[232:235], a[156:159], v[104:107]
    s_add_u32 s81, s81, 2048
    ds_read_b128 v[220:223], v58 offset:18432
    v_add_u32 v67, v3, v2
    v_mfma_f32_16x16x32_bf16 v[104:107], v[228:231], a[148:151], v[104:107]
    s_waitcnt lgkmcnt(3)
    buffer_load_dwordx4 v58, s[12:15], s82 offen offset:1024 sc1 lds
    v_mfma_f32_16x16x32_bf16 v[108:111], v[236:239], a[144:147], v[108:111]
    s_and_b32 s81, s81, 0x7fff
    ds_read_b128 v[224:227], v58 offset:19456
    s_lshr_b32 s45, s36, 1
    v_mfma_f32_16x16x32_bf16 v[108:111], v[240:243], a[152:155], v[108:111]
    s_mul_i32 s45, s45, 7808
    ds_read_b128 a[224:227], v76 offset:0
    s_add_u32 s45, s45, s46
    v_mfma_f32_16x16x32_bf16 v[112:115], v[240:243], a[156:159], v[112:115]
    s_add_u32 s45, s45, 118848
    ds_read_b128 v[228:231], v58 offset:20480
    v_lshl_add_u32 v2, v1, 1, v2
    v_mfma_f32_16x16x32_bf16 v[112:115], v[236:239], a[148:151], v[112:115]
    s_waitcnt lgkmcnt(4)
    ds_read_b128 a[228:231], v76 offset:2048
    v_and_b32 v1, 1, v0
    v_mfma_f32_16x16x32_bf16 v[84:87], v[212:215], a[160:163], v[84:87]
    ds_read_b128 v[232:235], v58 offset:21504
    v_mul_u32_u24 v1, 4158, v1
    v_mfma_f32_16x16x32_bf16 v[84:87], v[216:219], a[168:171], v[84:87]
    ds_read_b128 a[232:235], v77 offset:0
    v_sub_u32 v1, s45, v1
    v_mfma_f32_16x16x32_bf16 v[88:91], v[216:219], a[172:175], v[88:91]
    ds_read_b128 v[236:239], v58 offset:22528
    v_add_u32 v252, v1, v2
    v_mfma_f32_16x16x32_bf16 v[88:91], v[212:215], a[164:167], v[88:91]
    s_waitcnt lgkmcnt(6)
    ds_read_b128 a[236:239], v77 offset:2048
    v_add_u32 v253, 1024, v252
    v_mfma_f32_16x16x32_bf16 v[92:95], v[220:223], a[160:163], v[92:95]
    ds_read_b128 v[240:243], v58 offset:23552
    v_add_u32 v254, 2048, v252
    v_mfma_f32_16x16x32_bf16 v[92:95], v[224:227], a[168:171], v[92:95]
    v_add_u32 v255, 3072, v252
    s_mul_i32 s45, s36, 4160
    v_mfma_f32_16x16x32_bf16 v[96:99], v[224:227], a[172:175], v[96:99]
    s_add_u32 m0, s89, 155648
    ds_read_b128 v[212:215], v58 offset:24576
    s_add_u32 s82, s78, s81
    v_mfma_f32_16x16x32_bf16 v[96:99], v[220:223], a[164:167], v[96:99]
    s_waitcnt lgkmcnt(5)
    buffer_load_dwordx4 v58, s[12:15], s82 offen sc1 lds
    v_mfma_f32_16x16x32_bf16 v[100:103], v[228:231], a[160:163], v[100:103]
    s_add_u32 s81, s81, 4096
    ds_read_b128 v[216:219], v58 offset:25600
    s_add_u32 s45, s45, 114688
    v_mfma_f32_16x16x32_bf16 v[100:103], v[232:235], a[168:171], v[100:103]
    buffer_load_dwordx4 v58, s[12:15], s82 offen offset:1024 sc1 lds
    v_mfma_f32_16x16x32_bf16 v[104:107], v[232:235], a[172:175], v[104:107]
    s_and_b32 s81, s81, 0x7fff
    ds_read_b128 v[220:223], v58 offset:26624
    v_min_u32 v2, 7, v0
    v_mfma_f32_16x16x32_bf16 v[104:107], v[228:231], a[164:167], v[104:107]
    s_waitcnt lgkmcnt(3)
    v_lshl_add_u32 v2, v2, 2, s45
    s_lshr_b32 s45, s36, 1
    v_mfma_f32_16x16x32_bf16 v[108:111], v[236:239], a[160:163], v[108:111]
    s_mul_i32 s46, s45, 8320
    ds_read_b128 v[224:227], v58 offset:27648
    s_add_u32 s46, s46, 114688
    v_mfma_f32_16x16x32_bf16 v[108:111], v[240:243], a[168:171], v[108:111]
    v_mov_b32 v56, s46
    s_and_b32 s56, s36, 1
    v_mfma_f32_16x16x32_bf16 v[112:115], v[240:243], a[172:175], v[112:115]
    s_lshl_b32 s56, s56, 11
    ds_read_b128 v[228:231], v58 offset:28672
    s_add_u32 s74, s74, s56
    v_mfma_f32_16x16x32_bf16 v[112:115], v[236:239], a[164:167], v[112:115]
    s_waitcnt lgkmcnt(3)
    s_mul_i32 s57, s45, 4608
    s_add_u32 s57, s57, s56
    v_mfma_f32_16x16x32_bf16 v[84:87], v[212:215], a[176:179], v[84:87]
    s_add_u32 s56, s56, s46
    ds_read_b128 v[232:235], v58 offset:29696
    v_add_u32 v57, s56, v58
    v_mfma_f32_16x16x32_bf16 v[84:87], v[216:219], a[184:187], v[84:87]
    s_mul_i32 s45, s45, 4096
    s_lshl_b32 s46, s36, 8
    s_add_u32 s46, s46, s45
    v_mfma_f32_16x16x32_bf16 v[88:91], v[216:219], a[188:191], v[88:91]
    s_add_u32 s46, s46, 135424
    ds_read_b128 v[236:239], v58 offset:30720
    v_lshl_add_u32 v3, v0, 2, s46
    v_mfma_f32_16x16x32_bf16 v[88:91], v[212:215], a[180:183], v[88:91]
    s_waitcnt lgkmcnt(3)
    v_mfma_f32_16x16x32_bf16 v[92:95], v[220:223], a[176:179], v[92:95]
    ds_read_b128 v[240:243], v58 offset:31744
    v_mfma_f32_16x16x32_bf16 v[92:95], v[224:227], a[184:187], v[92:95]
    v_mfma_f32_16x16x32_bf16 v[96:99], v[224:227], a[188:191], v[96:99]
    s_waitcnt vmcnt(10)
    s_barrier
    ds_read_b128 v[212:215], v58 offset:32768
    v_mfma_f32_16x16x32_bf16 v[96:99], v[220:223], a[180:183], v[96:99]
    s_waitcnt lgkmcnt(3)
    s_add_u32 m0, s89, 8192
    s_add_u32 s82, s78, s81
    v_mfma_f32_16x16x32_bf16 v[100:103], v[228:231], a[176:179], v[100:103]
    s_waitcnt vmcnt(6)
    ds_read_b128 v[216:219], v58 offset:33792
    v_mfma_f32_16x16x32_bf16 v[100:103], v[232:235], a[184:187], v[100:103]
    buffer_load_dwordx4 v58, s[12:15], s82 offen sc1 lds
    v_mfma_f32_16x16x32_bf16 v[104:107], v[232:235], a[188:191], v[104:107]
    s_add_u32 s81, s81, 4096
    ds_read_b128 v[220:223], v58 offset:34816
    v_mfma_f32_16x16x32_bf16 v[104:107], v[228:231], a[180:183], v[104:107]
    s_waitcnt lgkmcnt(3)
    buffer_load_dwordx4 v58, s[12:15], s82 offen offset:1024 sc1 lds
    v_mfma_f32_16x16x32_bf16 v[108:111], v[236:239], a[176:179], v[108:111]
    s_and_b32 s81, s81, 0x7fff
    ds_read_b128 v[224:227], v58 offset:35840
    v_mfma_f32_16x16x32_bf16 v[108:111], v[240:243], a[184:187], v[108:111]
    ds_read_b128 a[240:243], v76 offset:4096
    v_mfma_f32_16x16x32_bf16 v[112:115], v[240:243], a[188:191], v[112:115]
    ds_read_b128 v[228:231], v58 offset:36864
    v_mfma_f32_16x16x32_bf16 v[112:115], v[236:239], a[180:183], v[112:115]
    s_waitcnt lgkmcnt(4)
    ds_read_b128 a[244:247], v76 offset:6144
    v_mfma_f32_16x16x32_bf16 v[84:87], v[212:215], a[192:195], v[84:87]
    ds_read_b128 v[232:235], v58 offset:37888
    v_mfma_f32_16x16x32_bf16 v[84:87], v[216:219], a[200:203], v[84:87]
    ds_read_b128 a[248:251], v77 offset:4096
    v_mfma_f32_16x16x32_bf16 v[88:91], v[216:219], a[204:207], v[88:91]
    ds_read_b128 v[236:239], v58 offset:38912
    v_mfma_f32_16x16x32_bf16 v[88:91], v[212:215], a[196:199], v[88:91]
    s_waitcnt lgkmcnt(6)
    ds_read_b128 a[252:255], v77 offset:6144
    v_mfma_f32_16x16x32_bf16 v[92:95], v[220:223], a[192:195], v[92:95]
    ds_read_b128 v[240:243], v58 offset:39936
    v_mfma_f32_16x16x32_bf16 v[92:95], v[224:227], a[200:203], v[92:95]
    v_mfma_f32_16x16x32_bf16 v[96:99], v[224:227], a[204:207], v[96:99]
    s_add_u32 m0, s89, 16384
    ds_read_b128 v[212:215], v58 offset:40960
    s_add_u32 s82, s78, s81
    v_mfma_f32_16x16x32_bf16 v[96:99], v[220:223], a[196:199], v[96:99]
    s_waitcnt lgkmcnt(5)
    buffer_load_dwordx4 v58, s[12:15], s82 offen sc1 lds
    v_mfma_f32_16x16x32_bf16 v[100:103], v[228:231], a[192:195], v[100:103]
    s_add_u32 s81, s81, 4096
    ds_read_b128 v[216:219], v58 offset:41984
    v_mfma_f32_16x16x32_bf16 v[100:103], v[232:235], a[200:203], v[100:103]
    buffer_load_dwordx4 v58, s[12:15], s82 offen offset:1024 sc1 lds
    v_mfma_f32_16x16x32_bf16 v[104:107], v[232:235], a[204:207], v[104:107]
    s_and_b32 s81, s81, 0x7fff
    ds_read_b128 v[220:223], v58 offset:43008
    v_mfma_f32_16x16x32_bf16 v[104:107], v[228:231], a[196:199], v[104:107]
    s_waitcnt lgkmcnt(3)
    v_mfma_f32_16x16x32_bf16 v[108:111], v[236:239], a[192:195], v[108:111]
    ds_read_b128 v[224:227], v58 offset:44032
    v_mfma_f32_16x16x32_bf16 v[108:111], v[240:243], a[200:203], v[108:111]
    v_mfma_f32_16x16x32_bf16 v[112:115], v[240:243], a[204:207], v[112:115]
    ds_read_b128 v[228:231], v58 offset:45056
    v_mfma_f32_16x16x32_bf16 v[112:115], v[236:239], a[196:199], v[112:115]
    s_waitcnt lgkmcnt(3)
    v_mfma_f32_16x16x32_bf16 v[84:87], v[212:215], a[208:211], v[84:87]
    ds_read_b128 v[232:235], v58 offset:46080
    v_mfma_f32_16x16x32_bf16 v[84:87], v[216:219], a[216:219], v[84:87]
    v_mfma_f32_16x16x32_bf16 v[88:91], v[216:219], a[220:223], v[88:91]
    ds_read_b128 v[236:239], v58 offset:47104
    v_mfma_f32_16x16x32_bf16 v[88:91], v[212:215], a[212:215], v[88:91]
    s_waitcnt lgkmcnt(3)
    v_mfma_f32_16x16x32_bf16 v[92:95], v[220:223], a[208:211], v[92:95]
    ds_read_b128 v[240:243], v58 offset:48128
    v_mfma_f32_16x16x32_bf16 v[92:95], v[224:227], a[216:219], v[92:95]
    v_mfma_f32_16x16x32_bf16 v[96:99], v[224:227], a[220:223], v[96:99]
    s_waitcnt vmcnt(6)
    s_barrier
    v_mfma_f32_16x16x32_bf16 v[96:99], v[220:223], a[212:215], v[96:99]
    s_waitcnt lgkmcnt(2)
    ds_read_b128 v[212:215], v58 offset:49152
    s_add_u32 m0, s89, 24576
    v_mfma_f32_16x16x32_bf16 v[100:103], v[228:231], a[208:211], v[100:103]
    s_add_u32 s82, s78, s81
    ds_read_b128 v[216:219], v58 offset:50176
    v_mfma_f32_16x16x32_bf16 v[100:103], v[232:235], a[216:219], v[100:103]
    buffer_load_dwordx4 v58, s[12:15], s82 offen sc1 lds
    v_mfma_f32_16x16x32_bf16 v[104:107], v[232:235], a[220:223], v[104:107]
    s_add_u32 s81, s81, 4096
    ds_read_b128 v[220:223], v58 offset:51200
    v_mfma_f32_16x16x32_bf16 v[104:107], v[228:231], a[212:215], v[104:107]
    s_waitcnt lgkmcnt(3)
    buffer_load_dwordx4 v58, s[12:15], s82 offen offset:1024 sc1 lds
    v_mfma_f32_16x16x32_bf16 v[108:111], v[236:239], a[208:211], v[108:111]
    s_and_b32 s81, s81, 0x7fff
    ds_read_b128 v[224:227], v58 offset:52224
    s_add_u32 m0, s89, 32768
    v_mfma_f32_16x16x32_bf16 v[108:111], v[240:243], a[216:219], v[108:111]
    s_add_u32 s82, s78, s81
    buffer_load_dwordx4 v58, s[12:15], s82 offen sc1 lds
    v_mfma_f32_16x16x32_bf16 v[112:115], v[240:243], a[220:223], v[112:115]
    s_add_u32 s81, s81, 4096
    ds_read_b128 v[228:231], v58 offset:53248
    v_mfma_f32_16x16x32_bf16 v[112:115], v[236:239], a[212:215], v[112:115]
    s_waitcnt lgkmcnt(3)
    buffer_load_dwordx4 v58, s[12:15], s82 offen offset:1024 sc1 lds
    v_mfma_f32_16x16x32_bf16 v[84:87], v[212:215], a[224:227], v[84:87]
    s_and_b32 s81, s81, 0x7fff
    ds_read_b128 v[232:235], v58 offset:54272
    v_mfma_f32_16x16x32_bf16 v[84:87], v[216:219], a[232:235], v[84:87]
    ds_write_b32 v2, v64
    v_mfma_f32_16x16x32_bf16 v[88:91], v[216:219], a[236:239], v[88:91]
    ds_read_b128 v[236:239], v58 offset:55296
    v_mfma_f32_16x16x32_bf16 v[88:91], v[212:215], a[228:231], v[88:91]
    s_waitcnt lgkmcnt(4)
    ds_write_b32 v3, v64
    v_mfma_f32_16x16x32_bf16 v[92:95], v[220:223], a[224:227], v[92:95]
    ds_read_b128 v[240:243], v58 offset:56320
    v_mfma_f32_16x16x32_bf16 v[92:95], v[224:227], a[232:235], v[92:95]
    v_mfma_f32_16x16x32_bf16 v[96:99], v[224:227], a[236:239], v[96:99]
    s_add_u32 m0, s89, 147456
    ds_read_b128 v[212:215], v58 offset:0
    s_add_u32 s82, s78, s81
    v_mfma_f32_16x16x32_bf16 v[96:99], v[220:223], a[228:231], v[96:99]
    s_waitcnt lgkmcnt(5)
    buffer_load_dwordx4 v58, s[12:15], s82 offen sc1 lds
    v_mfma_f32_16x16x32_bf16 v[100:103], v[228:231], a[224:227], v[100:103]
    s_add_u32 s81, s81, 4096
    ds_read_b128 v[216:219], v58 offset:1024
    v_mfma_f32_16x16x32_bf16 v[100:103], v[232:235], a[232:235], v[100:103]
    buffer_load_dwordx4 v58, s[12:15], s82 offen offset:1024 sc1 lds
    v_mfma_f32_16x16x32_bf16 v[104:107], v[232:235], a[236:239], v[104:107]
    s_and_b32 s81, s81, 0x7fff
    ds_read_b128 v[220:223], v58 offset:2048
    v_mfma_f32_16x16x32_bf16 v[104:107], v[228:231], a[228:231], v[104:107]
    s_waitcnt lgkmcnt(3)
    v_mfma_f32_16x16x32_bf16 v[108:111], v[236:239], a[224:227], v[108:111]
    ds_read_b128 v[224:227], v58 offset:3072
    v_mfma_f32_16x16x32_bf16 v[108:111], v[240:243], a[232:235], v[108:111]
    v_mfma_f32_16x16x32_bf16 v[112:115], v[240:243], a[236:239], v[112:115]
    ds_read_b128 v[228:231], v58 offset:4096
    v_mfma_f32_16x16x32_bf16 v[112:115], v[236:239], a[228:231], v[112:115]
    s_waitcnt lgkmcnt(3)
    v_mfma_f32_16x16x32_bf16 v[84:87], v[212:215], a[240:243], v[84:87]
    ds_read_b128 v[232:235], v58 offset:5120
    v_mfma_f32_16x16x32_bf16 v[84:87], v[216:219], a[248:251], v[84:87]
    v_mfma_f32_16x16x32_bf16 v[88:91], v[216:219], a[252:255], v[88:91]
    ds_read_b128 v[236:239], v58 offset:6144
    v_mfma_f32_16x16x32_bf16 v[88:91], v[212:215], a[244:247], v[88:91]
    s_waitcnt lgkmcnt(3)
    v_mfma_f32_16x16x32_bf16 v[92:95], v[220:223], a[240:243], v[92:95]
    ds_read_b128 v[240:243], v58 offset:7168
    v_mfma_f32_16x16x32_bf16 v[92:95], v[224:227], a[248:251], v[92:95]
    v_mfma_f32_16x16x32_bf16 v[96:99], v[224:227], a[252:255], v[96:99]
    s_waitcnt vmcnt(8)
    s_barrier
    ds_read_b128 v[212:215], v66 offset:24576
    v_mfma_f32_16x16x32_bf16 v[96:99], v[220:223], a[244:247], v[96:99]
    s_waitcnt lgkmcnt(3)
    s_add_u32 m0, s89, 40960
    s_add_u32 s82, s78, s81
    v_mfma_f32_16x16x32_bf16 v[100:103], v[228:231], a[240:243], v[100:103]
    ds_read_b128 v[216:219], v66 offset:25600
    v_mfma_f32_16x16x32_bf16 v[100:103], v[232:235], a[248:251], v[100:103]
    buffer_load_dwordx4 v58, s[12:15], s82 offen sc1 lds
    v_mfma_f32_16x16x32_bf16 v[104:107], v[232:235], a[252:255], v[104:107]
    s_add_u32 s81, s81, 4096
    ds_read_b128 v[220:223], v66 offset:26624
    v_mfma_f32_16x16x32_bf16 v[104:107], v[228:231], a[244:247], v[104:107]
    s_waitcnt lgkmcnt(3)
    buffer_load_dwordx4 v58, s[12:15], s82 offen offset:1024 sc1 lds
    v_mfma_f32_16x16x32_bf16 v[108:111], v[236:239], a[240:243], v[108:111]
    s_and_b32 s81, s81, 0x7fff
    ds_read_b128 v[224:227], v66 offset:27648
    v_mfma_f32_16x16x32_bf16 v[108:111], v[240:243], a[248:251], v[108:111]
    v_mfma_f32_16x16x32_bf16 v[112:115], v[240:243], a[252:255], v[112:115]
    ds_read_b128 v[228:231], v66 offset:28672
    v_mfma_f32_16x16x32_bf16 v[112:115], v[236:239], a[244:247], v[112:115]
    s_waitcnt lgkmcnt(3)
    v_mfma_f32_16x16x32_bf16 v[116:119], v[212:215], a[0:3], v[48:51]
    ds_read_b128 v[232:235], v66 offset:29696
    v_mfma_f32_16x16x32_bf16 v[116:119], v[216:219], a[8:11], v[116:119]
    v_mfma_f32_16x16x32_bf16 v[120:123], v[216:219], a[12:15], v[52:55]
    ds_read_b128 v[236:239], v66 offset:30720
    v_mfma_f32_16x16x32_bf16 v[120:123], v[212:215], a[4:7], v[120:123]
    s_waitcnt lgkmcnt(3)
    v_cvt_pk_bf16_f32 v84, v84, v85
    v_cvt_pk_bf16_f32 v85, v86, v87
    v_mfma_f32_16x16x32_bf16 v[120:123], v[220:223], a[20:23], v[120:123]
    ds_read_b128 v[240:243], v66 offset:31744
    v_cvt_pk_bf16_f32 v86, v88, v89
    v_mfma_f32_16x16x32_bf16 v[120:123], v[224:227], a[28:31], v[120:123]
    v_cvt_pk_bf16_f32 v87, v90, v91
    v_and_or_b32 v84, v84, s54, v72
    v_mfma_f32_16x16x32_bf16 v[116:119], v[224:227], a[24:27], v[116:119]
    s_add_u32 m0, s89, 49152
    ds_read_b128 v[212:215], v58 offset:8192
    s_add_u32 s82, s78, s81
    v_mfma_f32_16x16x32_bf16 v[116:119], v[220:223], a[16:19], v[116:119]
    s_waitcnt lgkmcnt(3)
    buffer_load_dwordx4 v58, s[12:15], s82 offen sc1 lds
    v_mfma_f32_16x16x32_bf16 v[124:127], v[228:231], a[0:3], v[48:51]
    s_add_u32 s81, s81, 4096
    ds_read_b128 v[216:219], v58 offset:9216
    v_and_or_b32 v85, v85, s54, v73
    v_mfma_f32_16x16x32_bf16 v[124:127], v[232:235], a[8:11], v[124:127]
    buffer_load_dwordx4 v58, s[12:15], s82 offen offset:1024 sc1 lds
    v_mfma_f32_16x16x32_bf16 v[128:131], v[232:235], a[12:15], v[52:55]
    s_and_b32 s81, s81, 0x7fff
    ds_read_b128 v[220:223], v58 offset:10240
    s_add_u32 s78, s78, 131072
    v_mfma_f32_16x16x32_bf16 v[128:131], v[228:231], a[4:7], v[128:131]
    s_waitcnt lgkmcnt(3)
    s_add_u32 m0, s56, 32
    v_and_or_b32 v86, v86, s54, v74
    v_mfma_f32_16x16x32_bf16 v[128:131], v[236:239], a[20:23], v[128:131]
    ds_read_b128 v[224:227], v58 offset:11264
    v_and_or_b32 v87, v87, s54, v75
    v_mfma_f32_16x16x32_bf16 v[128:131], v[240:243], a[28:31], v[128:131]
    buffer_load_dwordx4 v58, s[20:23], s74 offen  lds
    v_mfma_f32_16x16x32_bf16 v[124:127], v[240:243], a[24:27], v[124:127]
    ds_read_b128 v[228:231], v58 offset:12288
    v_mfma_f32_16x16x32_bf16 v[124:127], v[236:239], a[16:19], v[124:127]
    s_waitcnt lgkmcnt(3)
    buffer_store_dwordx4 v[84:87], v58, s[12:15], s75 offen offset:0 sc1
    v_mfma_f32_16x16x32_bf16 v[116:119], v[212:215], a[32:35], v[116:119]
    ds_read_b128 v[232:235], v58 offset:13312
    v_cvt_pk_bf16_f32 v92, v92, v93
    v_mfma_f32_16x16x32_bf16 v[116:119], v[216:219], a[40:43], v[116:119]
    buffer_load_dwordx4 v58, s[20:23], s74 offen offset:1024  lds
    v_mfma_f32_16x16x32_bf16 v[120:123], v[216:219], a[44:47], v[120:123]
    ds_read_b128 v[236:239], v58 offset:14336
    v_cvt_pk_bf16_f32 v93, v94, v95
    v_mfma_f32_16x16x32_bf16 v[120:123], v[212:215], a[36:39], v[120:123]
    s_waitcnt lgkmcnt(3)
    v_cvt_pk_bf16_f32 v94, v96, v97
    v_cvt_pk_bf16_f32 v95, v98, v99
    v_mfma_f32_16x16x32_bf16 v[120:123], v[220:223], a[52:55], v[120:123]
    ds_read_b128 v[240:243], v58 offset:15360
    v_and_or_b32 v92, v92, s54, v72
    v_mfma_f32_16x16x32_bf16 v[120:123], v[224:227], a[60:63], v[120:123]
    v_and_or_b32 v93, v93, s54, v73
    v_and_or_b32 v94, v94, s54, v74
    v_mfma_f32_16x16x32_bf16 v[116:119], v[224:227], a[56:59], v[116:119]
    s_waitcnt vmcnt(11)
    s_barrier
    ds_read_b128 v[212:215], v58 offset:16384
    v_mfma_f32_16x16x32_bf16 v[116:119], v[220:223], a[48:51], v[116:119]
    s_waitcnt lgkmcnt(3)
    v_and_or_b32 v95, v95, s54, v75
    v_mfma_f32_16x16x32_bf16 v[124:127], v[228:231], a[32:35], v[124:127]
    ds_read_b128 v[216:219], v58 offset:17408
    v_mfma_f32_16x16x32_bf16 v[124:127], v[232:235], a[40:43], v[124:127]
    buffer_store_dwordx4 v[92:95], v58, s[12:15], s75 offen offset:1024 sc1
    v_mfma_f32_16x16x32_bf16 v[128:131], v[232:235], a[44:47], v[128:131]
    ds_read_b128 v[220:223], v58 offset:18432
    v_cvt_pk_bf16_f32 v100, v100, v101
    v_mfma_f32_16x16x32_bf16 v[128:131], v[228:231], a[36:39], v[128:131]
    s_waitcnt lgkmcnt(3)
    v_cvt_pk_bf16_f32 v101, v102, v103
    v_cvt_pk_bf16_f32 v102, v104, v105
    v_mfma_f32_16x16x32_bf16 v[128:131], v[236:239], a[52:55], v[128:131]
    ds_read_b128 v[224:227], v58 offset:19456
    v_cvt_pk_bf16_f32 v103, v106, v107
    v_mfma_f32_16x16x32_bf16 v[128:131], v[240:243], a[60:63], v[128:131]
    v_and_or_b32 v100, v100, s54, v72
    v_and_or_b32 v101, v101, s54, v73
    v_mfma_f32_16x16x32_bf16 v[124:127], v[240:243], a[56:59], v[124:127]
    ds_read_b128 v[228:231], v58 offset:20480
    v_and_or_b32 v102, v102, s54, v74
    v_mfma_f32_16x16x32_bf16 v[124:127], v[236:239], a[48:51], v[124:127]
    s_waitcnt lgkmcnt(3)
    v_and_or_b32 v103, v103, s54, v75
    v_mfma_f32_16x16x32_bf16 v[116:119], v[212:215], a[64:67], v[116:119]
    ds_read_b128 v[232:235], v58 offset:21504
    v_mfma_f32_16x16x32_bf16 v[116:119], v[216:219], a[72:75], v[116:119]
    buffer_store_dwordx4 v[100:103], v58, s[12:15], s75 offen offset:2048 sc1
    v_mfma_f32_16x16x32_bf16 v[120:123], v[216:219], a[76:79], v[120:123]
    ds_read_b128 v[236:239], v58 offset:22528
    v_cvt_pk_bf16_f32 v108, v108, v109
    v_mfma_f32_16x16x32_bf16 v[120:123], v[212:215], a[68:71], v[120:123]
    s_waitcnt lgkmcnt(3)
    v_cvt_pk_bf16_f32 v109, v110, v111
    v_cvt_pk_bf16_f32 v110, v112, v113
    v_mfma_f32_16x16x32_bf16 v[120:123], v[220:223], a[84:87], v[120:123]
    ds_read_b128 v[240:243], v58 offset:23552
    v_cvt_pk_bf16_f32 v111, v114, v115
    v_mfma_f32_16x16x32_bf16 v[120:123], v[224:227], a[92:95], v[120:123]
    v_and_or_b32 v108, v108, s54, v72
    v_and_or_b32 v109, v109, s54, v73
    v_mfma_f32_16x16x32_bf16 v[116:119], v[224:227], a[88:91], v[116:119]
    ds_read_b128 v[212:215], v58 offset:24576
    v_and_or_b32 v110, v110, s54, v74
    v_mfma_f32_16x16x32_bf16 v[116:119], v[220:223], a[80:83], v[116:119]
    s_waitcnt lgkmcnt(3)
    v_and_or_b32 v111, v111, s54, v75
    v_mfma_f32_16x16x32_bf16 v[124:127], v[228:231], a[64:67], v[124:127]
    ds_read_b128 v[216:219], v58 offset:25600
    v_mfma_f32_16x16x32_bf16 v[124:127], v[232:235], a[72:75], v[124:127]
    buffer_store_dwordx4 v[108:111], v58, s[12:15], s75 offen offset:3072 sc1
    v_mfma_f32_16x16x32_bf16 v[128:131], v[232:235], a[76:79], v[128:131]
    ds_read_b128 v[220:223], v58 offset:26624
    v_mfma_f32_16x16x32_bf16 v[128:131], v[228:231], a[68:71], v[128:131]
    s_waitcnt lgkmcnt(3)
    v_mfma_f32_16x16x32_bf16 v[128:131], v[236:239], a[84:87], v[128:131]
    ds_read_b128 v[224:227], v58 offset:27648
    v_mfma_f32_16x16x32_bf16 v[128:131], v[240:243], a[92:95], v[128:131]
    v_mfma_f32_16x16x32_bf16 v[124:127], v[240:243], a[88:91], v[124:127]
    ds_read_b128 v[228:231], v58 offset:28672
    v_mfma_f32_16x16x32_bf16 v[124:127], v[236:239], a[80:83], v[124:127]
    s_waitcnt lgkmcnt(3)
    v_mfma_f32_16x16x32_bf16 v[116:119], v[212:215], a[96:99], v[116:119]
    ds_read_b128 v[232:235], v58 offset:29696
    v_mfma_f32_16x16x32_bf16 v[116:119], v[216:219], a[104:107], v[116:119]
    v_mfma_f32_16x16x32_bf16 v[120:123], v[216:219], a[108:111], v[120:123]
    ds_read_b128 v[236:239], v58 offset:30720
    v_mfma_f32_16x16x32_bf16 v[120:123], v[212:215], a[100:103], v[120:123]
    s_waitcnt lgkmcnt(3)
    v_mfma_f32_16x16x32_bf16 v[120:123], v[220:223], a[116:119], v[120:123]
    ds_read_b128 v[240:243], v58 offset:31744
    v_mfma_f32_16x16x32_bf16 v[120:123], v[224:227], a[124:127], v[120:123]
    v_mfma_f32_16x16x32_bf16 v[116:119], v[224:227], a[120:123], v[116:119]
    s_waitcnt vmcnt(10)
    s_barrier
    ds_read_b128 v[212:215], v58 offset:32768
    v_mfma_f32_16x16x32_bf16 v[116:119], v[220:223], a[112:115], v[116:119]
    s_waitcnt lgkmcnt(3)
    s_mov_b32 m0, s89
    s_add_u32 s82, s78, s81
    v_mfma_f32_16x16x32_bf16 v[124:127], v[228:231], a[96:99], v[124:127]
    ds_read_b128 v[216:219], v58 offset:33792
    v_mfma_f32_16x16x32_bf16 v[124:127], v[232:235], a[104:107], v[124:127]
    buffer_load_dwordx4 v58, s[12:15], s82 offen sc1 lds
    v_mfma_f32_16x16x32_bf16 v[128:131], v[232:235], a[108:111], v[128:131]
    s_add_u32 s81, s81, 4096
    ds_read_b128 v[220:223], v58 offset:34816
    v_mfma_f32_16x16x32_bf16 v[128:131], v[228:231], a[100:103], v[128:131]
    s_waitcnt lgkmcnt(3)
    buffer_load_dwordx4 v58, s[12:15], s82 offen offset:1024 sc1 lds
    v_mfma_f32_16x16x32_bf16 v[128:131], v[236:239], a[116:119], v[128:131]
    s_and_b32 s81, s81, 0x7fff
    ds_read_b128 v[224:227], v58 offset:35840
    v_mfma_f32_16x16x32_bf16 v[128:131], v[240:243], a[124:127], v[128:131]
    v_mfma_f32_16x16x32_bf16 v[124:127], v[240:243], a[120:123], v[124:127]
    ds_read_b128 v[228:231], v58 offset:36864
    v_mfma_f32_16x16x32_bf16 v[124:127], v[236:239], a[112:115], v[124:127]
    s_waitcnt lgkmcnt(3)
    v_mfma_f32_16x16x32_bf16 v[116:119], v[212:215], a[128:131], v[116:119]
    ds_read_b128 v[232:235], v58 offset:37888
    v_mfma_f32_16x16x32_bf16 v[116:119], v[216:219], a[136:139], v[116:119]
    v_mfma_f32_16x16x32_bf16 v[120:123], v[216:219], a[140:143], v[120:123]
    ds_read_b128 v[236:239], v58 offset:38912
    v_mfma_f32_16x16x32_bf16 v[120:123], v[212:215], a[132:135], v[120:123]
    s_waitcnt lgkmcnt(3)
    v_mfma_f32_16x16x32_bf16 v[120:123], v[220:223], a[148:151], v[120:123]
    ds_read_b128 v[240:243], v58 offset:39936
    v_mfma_f32_16x16x32_bf16 v[120:123], v[224:227], a[156:159], v[120:123]
    v_mfma_f32_16x16x32_bf16 v[116:119], v[224:227], a[152:155], v[116:119]
    s_add_u32 m0, s89, 155648
    ds_read_b128 v[212:215], v66 offset:16384
    s_add_u32 s82, s78, s81
    v_mfma_f32_16x16x32_bf16 v[116:119], v[220:223], a[144:147], v[116:119]
    s_waitcnt lgkmcnt(3)
    buffer_load_dwordx4 v58, s[12:15], s82 offen sc1 lds
    v_mfma_f32_16x16x32_bf16 v[124:127], v[228:231], a[128:131], v[124:127]
    s_add_u32 s81, s81, 4096
    ds_read_b128 v[216:219], v66 offset:17408
    v_mfma_f32_16x16x32_bf16 v[124:127], v[232:235], a[136:139], v[124:127]
    buffer_load_dwordx4 v58, s[12:15], s82 offen offset:1024 sc1 lds
L_pad4:
    s_cbranch_execz L_warm
    v_mfma_f32_16x16x32_bf16 v[128:131], v[232:235], a[140:143], v[128:131]
    s_and_b32 s81, s81, 0x7fff
    ds_read_b128 v[220:223], v66 offset:18432
    v_mfma_f32_16x16x32_bf16 v[128:131], v[228:231], a[132:135], v[128:131]
    s_waitcnt lgkmcnt(3)
    v_mfma_f32_16x16x32_bf16 v[128:131], v[236:239], a[148:151], v[128:131]
    ds_read_b128 v[224:227], v66 offset:19456
    v_mfma_f32_16x16x32_bf16 v[128:131], v[240:243], a[156:159], v[128:131]
    v_mfma_f32_16x16x32_bf16 v[124:127], v[240:243], a[152:155], v[124:127]
    ds_read_b128 v[228:231], v66 offset:20480
    v_mfma_f32_16x16x32_bf16 v[124:127], v[236:239], a[144:147], v[124:127]
    s_waitcnt lgkmcnt(3)
    v_mfma_f32_16x16x32_bf16 v[116:119], v[212:215], a[160:163], v[116:119]
    ds_read_b128 v[232:235], v66 offset:21504
    v_mfma_f32_16x16x32_bf16 v[116:119], v[216:219], a[168:171], v[116:119]
    v_mfma_f32_16x16x32_bf16 v[120:123], v[216:219], a[172:175], v[120:123]
    ds_read_b128 v[236:239], v66 offset:22528
    v_mfma_f32_16x16x32_bf16 v[120:123], v[212:215], a[164:167], v[120:123]
    s_waitcnt lgkmcnt(3)
    v_mfma_f32_16x16x32_bf16 v[120:123], v[220:223], a[180:183], v[120:123]
    ds_read_b128 v[240:243], v66 offset:23552
    v_mfma_f32_16x16x32_bf16 v[120:123], v[224:227], a[188:191], v[120:123]
    v_mfma_f32_16x16x32_bf16 v[116:119], v[224:227], a[184:187], v[116:119]
    s_waitcnt vmcnt(10)
    s_barrier
    ds_read_b128 v[212:215], v58 offset:40960
    v_mfma_f32_16x16x32_bf16 v[116:119], v[220:223], a[176:179], v[116:119]
    s_waitcnt lgkmcnt(3)
    s_add_u32 m0, s89, 8192
    s_add_u32 s82, s78, s81
    v_mfma_f32_16x16x32_bf16 v[124:127], v[228:231], a[160:163], v[124:127]
    ds_read_b128 v[216:219], v58 offset:41984
    v_mfma_f32_16x16x32_bf16 v[124:127], v[232:235], a[168:171], v[124:127]
    buffer_load_dwordx4 v58, s[12:15], s82 offen sc1 lds
    v_mfma_f32_16x16x32_bf16 v[128:131], v[232:235], a[172:175], v[128:131]
    s_add_u32 s81, s81, 4096
    ds_read_b128 v[220:223], v58 offset:43008
    v_mfma_f32_16x16x32_bf16 v[128:131], v[228:231], a[164:167], v[128:131]
    s_waitcnt lgkmcnt(3)
    buffer_load_dwordx4 v58, s[12:15], s82 offen offset:1024 sc1 lds
    v_mfma_f32_16x16x32_bf16 v[128:131], v[236:239], a[180:183], v[128:131]
    s_and_b32 s81, s81, 0x7fff
    ds_read_b128 v[224:227], v58 offset:44032
    v_mfma_f32_16x16x32_bf16 v[128:131], v[240:243], a[188:191], v[128:131]
    v_mfma_f32_16x16x32_bf16 v[124:127], v[240:243], a[184:187], v[124:127]
    ds_read_b128 v[228:231], v58 offset:45056
    v_mfma_f32_16x16x32_bf16 v[124:127], v[236:239], a[176:179], v[124:127]
    s_waitcnt lgkmcnt(3)
    v_mfma_f32_16x16x32_bf16 v[116:119], v[212:215], a[192:195], v[116:119]
    ds_read_b128 v[232:235], v58 offset:46080
    v_mfma_f32_16x16x32_bf16 v[116:119], v[216:219], a[200:203], v[116:119]
    v_mfma_f32_16x16x32_bf16 v[120:123], v[216:219], a[204:207], v[120:123]
    ds_read_b128 v[236:239], v58 offset:47104
    v_mfma_f32_16x16x32_bf16 v[120:123], v[212:215], a[196:199], v[120:123]
    s_waitcnt lgkmcnt(3)
    v_mfma_f32_16x16x32_bf16 v[120:123], v[220:223], a[212:215], v[120:123]
    ds_read_b128 v[240:243], v58 offset:48128
    v_mfma_f32_16x16x32_bf16 v[120:123], v[224:227], a[220:223], v[120:123]
    v_mfma_f32_16x16x32_bf16 v[116:119], v[224:227], a[216:219], v[116:119]
    s_add_u32 m0, s89, 16384
    ds_read_b128 v[212:215], v58 offset:49152
    s_add_u32 s82, s78, s81
    v_mfma_f32_16x16x32_bf16 v[116:119], v[220:223], a[208:211], v[116:119]
    s_waitcnt lgkmcnt(3)
    buffer_load_dwordx4 v58, s[12:15], s82 offen sc1 lds
    v_mfma_f32_16x16x32_bf16 v[124:127], v[228:231], a[192:195], v[124:127]
    s_add_u32 s81, s81, 4096
    ds_read_b128 v[216:219], v58 offset:50176
    v_mfma_f32_16x16x32_bf16 v[124:127], v[232:235], a[200:203], v[124:127]
    buffer_load_dwordx4 v58, s[12:15], s82 offen offset:1024 sc1 lds
    v_mfma_f32_16x16x32_bf16 v[128:131], v[232:235], a[204:207], v[128:131]
    s_and_b32 s81, s81, 0x7fff
    ds_read_b128 v[220:223], v58 offset:51200
    v_mfma_f32_16x16x32_bf16 v[128:131], v[228:231], a[196:199], v[128:131]
    s_waitcnt lgkmcnt(3)
    v_mfma_f32_16x16x32_bf16 v[128:131], v[236:239], a[212:215], v[128:131]
    ds_read_b128 v[224:227], v58 offset:52224
    v_mfma_f32_16x16x32_bf16 v[128:131], v[240:243], a[220:223], v[128:131]
    v_mfma_f32_16x16x32_bf16 v[124:127], v[240:243], a[216:219], v[124:127]
    ds_read_b128 v[228:231], v58 offset:53248
    v_mfma_f32_16x16x32_bf16 v[124:127], v[236:239], a[208:211], v[124:127]
    s_waitcnt lgkmcnt(3)
    v_mfma_f32_16x16x32_bf16 v[116:119], v[212:215], a[224:227], v[116:119]
    ds_read_b128 v[232:235], v58 offset:54272
    v_mfma_f32_16x16x32_bf16 v[116:119], v[216:219], a[232:235], v[116:119]
    v_mfma_f32_16x16x32_bf16 v[120:123], v[216:219], a[236:239], v[120:123]
    ds_read_b128 v[236:239], v58 offset:55296
    v_mfma_f32_16x16x32_bf16 v[120:123], v[212:215], a[228:231], v[120:123]
    s_waitcnt lgkmcnt(3)
    v_mfma_f32_16x16x32_bf16 v[120:123], v[220:223], a[244:247], v[120:123]
    ds_read_b128 v[240:243], v58 offset:56320
    v_mfma_f32_16x16x32_bf16 v[120:123], v[224:227], a[252:255], v[120:123]
    v_mfma_f32_16x16x32_bf16 v[116:119], v[224:227], a[248:251], v[116:119]
    s_waitcnt vmcnt(4)
    s_barrier
    v_mfma_f32_16x16x32_bf16 v[116:119], v[220:223], a[240:243], v[116:119]
    s_waitcnt lgkmcnt(2)
    ds_read_b128 v[212:215], v58 offset:0
    s_add_u32 m0, s89, 147456
    v_mfma_f32_16x16x32_bf16 v[124:127], v[228:231], a[224:227], v[124:127]
    s_add_u32 s82, s78, s81
    ds_read_b128 v[216:219], v58 offset:1024
    v_mfma_f32_16x16x32_bf16 v[124:127], v[232:235], a[232:235], v[124:127]
    buffer_load_dwordx4 v58, s[12:15], s82 offen sc1 lds
    v_mfma_f32_16x16x32_bf16 v[128:131], v[232:235], a[236:239], v[128:131]
    s_add_u32 s81, s81, 4096
    ds_read_b128 v[220:223], v58 offset:2048
    s_mov_b32 s86, 131072
    v_mfma_f32_16x16x32_bf16 v[128:131], v[228:231], a[228:231], v[128:131]
    s_waitcnt lgkmcnt(3)
    buffer_load_dwordx4 v58, s[12:15], s82 offen offset:1024 sc1 lds
    v_mfma_f32_16x16x32_bf16 v[128:131], v[236:239], a[244:247], v[128:131]
    s_and_b32 s81, s81, 0x7fff
    ds_read_b128 v[224:227], v58 offset:3072
    v_mfma_f32_16x16x32_bf16 v[128:131], v[240:243], a[252:255], v[128:131]
    buffer_load_dword v61, v80, s[12:15], s86 offen sc1
    v_mfma_f32_16x16x32_bf16 v[124:127], v[240:243], a[248:251], v[124:127]
    ds_read_b128 v[228:231], v58 offset:4096
    v_mfma_f32_16x16x32_bf16 v[124:127], v[236:239], a[240:243], v[124:127]
    s_waitcnt lgkmcnt(3)
    ds_read_u16 v62, v56 offset:32
    v_mfma_f32_16x16x32_bf16 v[132:135], v[212:215], a[0:3], v[48:51]
    ds_read_b128 v[232:235], v58 offset:5120
    v_mfma_f32_16x16x32_bf16 v[132:135], v[216:219], a[8:11], v[132:135]
    ds_read_b128 v[148:151], v57 offset:32
    v_mfma_f32_16x16x32_bf16 v[136:139], v[216:219], a[12:15], v[52:55]
    ds_read_b128 v[236:239], v58 offset:6144
    v_mfma_f32_16x16x32_bf16 v[136:139], v[212:215], a[4:7], v[136:139]
    s_waitcnt lgkmcnt(5)
    ds_read_b32 v152, v57 offset:48
    v_mul_f32 v116, v116, v16
    v_mfma_f32_16x16x32_bf16 v[136:139], v[220:223], a[20:23], v[136:139]
    ds_read_b128 v[240:243], v58 offset:7168
    v_mul_f32 v117, v117, v17
    v_mfma_f32_16x16x32_bf16 v[136:139], v[224:227], a[28:31], v[136:139]
    ds_read_b128 v[156:159], v57 offset:1056
    v_mul_f32 v118, v118, v18
    v_mfma_f32_16x16x32_bf16 v[132:135], v[224:227], a[24:27], v[132:135]
    s_add_u32 m0, s89, 24576
    ds_read_b128 v[212:215], v66 offset:24576
    s_add_u32 s82, s78, s81
    v_mfma_f32_16x16x32_bf16 v[132:135], v[220:223], a[16:19], v[132:135]
    s_waitcnt lgkmcnt(6)
    buffer_load_dwordx4 v58, s[12:15], s82 offen sc1 lds
    v_mfma_f32_16x16x32_bf16 v[140:143], v[228:231], a[0:3], v[48:51]
    s_add_u32 s81, s81, 4096
    ds_read_b128 v[216:219], v66 offset:25600
    v_mul_f32 v119, v119, v19
    v_mfma_f32_16x16x32_bf16 v[140:143], v[232:235], a[8:11], v[140:143]
    buffer_load_dwordx4 v58, s[12:15], s82 offen offset:1024 sc1 lds
    v_mfma_f32_16x16x32_bf16 v[144:147], v[232:235], a[12:15], v[52:55]
    s_and_b32 s81, s81, 0x7fff
    ds_read_b128 v[220:223], v66 offset:26624
    v_mul_f32 v120, v120, v32
    v_mfma_f32_16x16x32_bf16 v[144:147], v[228:231], a[4:7], v[144:147]
    s_waitcnt lgkmcnt(4)
    buffer_load_dwordx4 v[88:91], v58, s[12:15], s76 offen offset:0 sc1
    v_mfma_f32_16x16x32_bf16 v[144:147], v[236:239], a[20:23], v[144:147]
    ds_read_b128 v[224:227], v66 offset:27648
    v_mul_f32 v121, v121, v33
    v_mfma_f32_16x16x32_bf16 v[144:147], v[240:243], a[28:31], v[144:147]
    buffer_load_dwordx4 v[96:99], v58, s[12:15], s76 offen offset:1024 sc1
    v_mfma_f32_16x16x32_bf16 v[140:143], v[240:243], a[24:27], v[140:143]
    ds_read_b128 v[228:231], v66 offset:28672
    v_mul_f32 v122, v122, v34
    v_mfma_f32_16x16x32_bf16 v[140:143], v[236:239], a[16:19], v[140:143]
    s_waitcnt lgkmcnt(3)
    buffer_load_dwordx4 v[104:107], v58, s[12:15], s76 offen offset:2048 sc1
    v_mfma_f32_16x16x32_bf16 v[132:135], v[212:215], a[32:35], v[132:135]
    ds_read_b128 v[232:235], v66 offset:29696
    v_mul_f32 v123, v123, v35
    v_mfma_f32_16x16x32_bf16 v[132:135], v[216:219], a[40:43], v[132:135]
    buffer_load_dwordx4 v[112:115], v58, s[12:15], s76 offen offset:3072 sc1
    v_mfma_f32_16x16x32_bf16 v[136:139], v[216:219], a[44:47], v[136:139]
    ds_read_b128 v[236:239], v66 offset:30720
    v_mul_f32 v124, v124, v20
    v_mfma_f32_16x16x32_bf16 v[136:139], v[212:215], a[36:39], v[136:139]
    s_waitcnt lgkmcnt(3)
    ds_read_b32 v160, v57 offset:1072
    v_mul_f32 v125, v125, v21
    v_mfma_f32_16x16x32_bf16 v[136:139], v[220:223], a[52:55], v[136:139]
    ds_read_b128 v[240:243], v66 offset:31744
    v_mul_f32 v126, v126, v22
    v_mfma_f32_16x16x32_bf16 v[136:139], v[224:227], a[60:63], v[136:139]
    v_mul_f32 v127, v127, v23
    v_mul_f32 v128, v128, v36
    v_mfma_f32_16x16x32_bf16 v[132:135], v[224:227], a[56:59], v[132:135]
    s_waitcnt vmcnt(9)
    s_barrier
    ds_read_b128 v[212:215], v58 offset:8192
    v_mfma_f32_16x16x32_bf16 v[132:135], v[220:223], a[48:51], v[132:135]
    s_waitcnt lgkmcnt(4)
    s_mov_b32 m0, s89
    s_add_u32 s82, s78, s81
    v_mfma_f32_16x16x32_bf16 v[140:143], v[228:231], a[32:35], v[140:143]
    ds_read_b128 v[216:219], v58 offset:9216
    v_mul_f32 v129, v129, v37
    v_mfma_f32_16x16x32_bf16 v[140:143], v[232:235], a[40:43], v[140:143]
    buffer_load_dwordx4 v58, s[12:15], s82 offen sc1 lds
    v_mfma_f32_16x16x32_bf16 v[144:147], v[232:235], a[44:47], v[144:147]
    s_add_u32 s81, s81, 4096
    ds_read_b128 v[220:223], v58 offset:10240
    v_mul_f32 v130, v130, v38
    v_mfma_f32_16x16x32_bf16 v[144:147], v[228:231], a[36:39], v[144:147]
    s_waitcnt lgkmcnt(3)
    buffer_load_dwordx4 v58, s[12:15], s82 offen offset:1024 sc1 lds
    v_mfma_f32_16x16x32_bf16 v[144:147], v[236:239], a[52:55], v[144:147]
    s_and_b32 s81, s81, 0x7fff
    ds_read_b128 v[224:227], v58 offset:11264
    v_mfma_f32_16x16x32_bf16 v[144:147], v[240:243], a[60:63], v[144:147]
    v_alignbit_b32 v148, v149, v148, 16
    v_alignbit_b32 v149, v150, v149, 16
    v_mfma_f32_16x16x32_bf16 v[140:143], v[240:243], a[56:59], v[140:143]
    ds_read_b128 v[228:231], v58 offset:12288
    v_alignbit_b32 v150, v151, v150, 16
    v_mfma_f32_16x16x32_bf16 v[140:143], v[236:239], a[48:51], v[140:143]
    s_waitcnt lgkmcnt(3)
    v_alignbit_b32 v151, v152, v151, 16
    v_alignbit_b32 v156, v157, v156, 16
    v_mfma_f32_16x16x32_bf16 v[132:135], v[212:215], a[64:67], v[132:135]
    ds_read_b128 v[232:235], v58 offset:13312
    v_alignbit_b32 v157, v158, v157, 16
    v_mfma_f32_16x16x32_bf16 v[132:135], v[216:219], a[72:75], v[132:135]
    v_alignbit_b32 v158, v159, v158, 16
    v_alignbit_b32 v159, v160, v159, 16
    v_mfma_f32_16x16x32_bf16 v[136:139], v[216:219], a[76:79], v[136:139]
    ds_read_b128 v[236:239], v58 offset:14336
    v_lshlrev_b32 v62, 16, v62
    v_mfma_f32_16x16x32_bf16 v[136:139], v[212:215], a[68:71], v[136:139]
    s_waitcnt lgkmcnt(3)
    ds_write_b64 v57, v[148:149] offset:4192
    v_mfma_f32_16x16x32_bf16 v[136:139], v[220:223], a[84:87], v[136:139]
    ds_read_b128 v[240:243], v58 offset:15360
    v_mul_f32 v131, v131, v39
    v_mfma_f32_16x16x32_bf16 v[136:139], v[224:227], a[92:95], v[136:139]
    ds_write_b64 v57, v[150:151] offset:4200
    v_mfma_f32_16x16x32_bf16 v[132:135], v[224:227], a[88:91], v[132:135]
    s_add_u32 m0, s89, 32768
    ds_read_b128 v[212:215], v58 offset:16384
    s_add_u32 s82, s78, s81
    v_mfma_f32_16x16x32_bf16 v[132:135], v[220:223], a[80:83], v[132:135]
    s_waitcnt lgkmcnt(5)
    buffer_load_dwordx4 v58, s[12:15], s82 offen sc1 lds
    v_mfma_f32_16x16x32_bf16 v[140:143], v[228:231], a[64:67], v[140:143]
    s_add_u32 s81, s81, 4096
    ds_read_b128 v[216:219], v58 offset:17408
    v_mfma_f32_16x16x32_bf16 v[140:143], v[232:235], a[72:75], v[140:143]
    buffer_load_dwordx4 v58, s[12:15], s82 offen offset:1024 sc1 lds
    v_mfma_f32_16x16x32_bf16 v[144:147], v[232:235], a[76:79], v[144:147]
    s_and_b32 s81, s81, 0x7fff
    ds_read_b128 v[220:223], v58 offset:18432
    v_mfma_f32_16x16x32_bf16 v[144:147], v[228:231], a[68:71], v[144:147]
    s_waitcnt lgkmcnt(4)
    ds_write_b64 v57, v[156:157] offset:5216
    v_mfma_f32_16x16x32_bf16 v[144:147], v[236:239], a[84:87], v[144:147]
    s_waitcnt vmcnt(10)
    ds_read_b128 v[224:227], v58 offset:19456
    v_cmp_ne_u32 vcc, s43, v61
    v_mfma_f32_16x16x32_bf16 v[144:147], v[240:243], a[92:95], v[144:147]
    ds_write_b64 v57, v[158:159] offset:5224
    v_mfma_f32_16x16x32_bf16 v[140:143], v[240:243], a[88:91], v[140:143]
    s_nop 1
    s_cbranch_vccnz L_slow_7
L_back_8:
    ds_read_b128 v[228:231], v58 offset:20480
    v_mfma_f32_16x16x32_bf16 v[140:143], v[236:239], a[80:83], v[140:143]
    s_waitcnt lgkmcnt(5)
    ds_write_b32 v56, v62 offset:4188
    v_mfma_f32_16x16x32_bf16 v[132:135], v[212:215], a[96:99], v[132:135]
    ds_read_b128 v[232:235], v58 offset:21504
    v_mfma_f32_16x16x32_bf16 v[132:135], v[216:219], a[104:107], v[132:135]
    v_mfma_f32_16x16x32_bf16 v[136:139], v[216:219], a[108:111], v[136:139]
    ds_read_b128 v[236:239], v58 offset:22528
    v_mfma_f32_16x16x32_bf16 v[136:139], v[212:215], a[100:103], v[136:139]
    s_waitcnt lgkmcnt(5)
    v_mfma_f32_16x16x32_bf16 v[136:139], v[220:223], a[116:119], v[136:139]
    ds_read_b128 v[240:243], v58 offset:23552
    v_mfma_f32_16x16x32_bf16 v[136:139], v[224:227], a[124:127], v[136:139]
    s_waitcnt lgkmcnt(3)
    v_mfma_f32_16x16x32_bf16 v[132:135], v[224:227], a[120:123], v[132:135]
    s_waitcnt vmcnt(8)
    s_barrier
    ds_read_b128 v[212:215], v66 offset:16384
    v_mfma_f32_16x16x32_bf16 v[132:135], v[220:223], a[112:115], v[132:135]
    s_waitcnt lgkmcnt(3)
    s_lshl2_add_u32 s47, s42, s36
    s_lshl_b32 s47, s47, 11
    v_mfma_f32_16x16x32_bf16 v[140:143], v[228:231], a[96:99], v[140:143]
    s_add_u32 m0, s57, 131328
    ds_read_b128 v[216:219], v66 offset:17408
    s_add_u32 s47, s47, 1048576
    v_mfma_f32_16x16x32_bf16 v[140:143], v[232:235], a[104:107], v[140:143]
    buffer_load_dwordx4 v58, s[12:15], s47 offen sc1 lds
    v_mfma_f32_16x16x32_bf16 v[144:147], v[232:235], a[108:111], v[144:147]
    ds_read_b128 v[220:223], v66 offset:18432
    v_mfma_f32_16x16x32_bf16 v[144:147], v[228:231], a[100:103], v[144:147]
    s_waitcnt lgkmcnt(3)
    v_mfma_f32_16x16x32_bf16 v[144:147], v[236:239], a[116:119], v[144:147]
    ds_read_b128 v[224:227], v66 offset:19456
    v_mfma_f32_16x16x32_bf16 v[144:147], v[240:243], a[124:127], v[144:147]
    buffer_load_dwordx4 v58, s[12:15], s47 offen offset:1024 sc1 lds
    v_mfma_f32_16x16x32_bf16 v[140:143], v[240:243], a[120:123], v[140:143]
    ds_read_b128 v[228:231], v66 offset:20480
    v_mfma_f32_16x16x32_bf16 v[140:143], v[236:239], a[112:115], v[140:143]
    s_waitcnt lgkmcnt(3)
    v_mfma_f32_16x16x32_bf16 v[132:135], v[212:215], a[128:131], v[132:135]
    ds_read_b128 v[232:235], v66 offset:21504
    v_mfma_f32_16x16x32_bf16 v[132:135], v[216:219], a[136:139], v[132:135]
    v_mfma_f32_16x16x32_bf16 v[136:139], v[216:219], a[140:143], v[136:139]
    s_waitcnt vmcnt(8)
    ds_read_b128 v[236:239], v66 offset:22528
    v_xor_b32 v1, v88, v72
    v_mfma_f32_16x16x32_bf16 v[136:139], v[212:215], a[132:135], v[136:139]
    s_waitcnt lgkmcnt(3)
    v_bitop3_b32 v1, v1, v89, v73 bitop3:0xf6
    v_bitop3_b32 v1, v1, v90, v74 bitop3:0xf6
    v_mfma_f32_16x16x32_bf16 v[136:139], v[220:223], a[148:151], v[136:139]
    ds_read_b128 v[240:243], v66 offset:23552
    v_bitop3_b32 v1, v1, v91, v75 bitop3:0xf6
    v_mfma_f32_16x16x32_bf16 v[136:139], v[224:227], a[156:159], v[136:139]
    v_bitop3_b32 v1, v1, v96, v72 bitop3:0xf6
    v_bitop3_b32 v1, v1, v97, v73 bitop3:0xf6
    v_mfma_f32_16x16x32_bf16 v[132:135], v[224:227], a[152:155], v[132:135]
    s_add_u32 s47, s84, 24
    ds_read_b128 v[212:215], v58 offset:24576
    s_sub_u32 s48, s47, 28
    v_mfma_f32_16x16x32_bf16 v[132:135], v[220:223], a[144:147], v[132:135]
    s_waitcnt lgkmcnt(3)
    s_min_u32 s47, s47, s48
    s_add_u32 m0, s85, 98304
    v_mfma_f32_16x16x32_bf16 v[140:143], v[228:231], a[128:131], v[140:143]
    s_lshl_b32 s47, s47, 12
    ds_read_b128 v[216:219], v58 offset:25600
    v_bitop3_b32 v1, v1, v98, v74 bitop3:0xf6
    v_mfma_f32_16x16x32_bf16 v[140:143], v[232:235], a[136:139], v[140:143]
    buffer_load_dwordx4 v65, s[12:15], s47 offen sc1 lds
    v_mfma_f32_16x16x32_bf16 v[144:147], v[232:235], a[140:143], v[144:147]
    ds_read_b128 v[220:223], v58 offset:26624
    v_bitop3_b32 v1, v1, v99, v75 bitop3:0xf6
    v_mfma_f32_16x16x32_bf16 v[144:147], v[228:231], a[132:135], v[144:147]
    s_waitcnt lgkmcnt(3)
    v_and_b32 v1, 0x00010001, v1
    v_cmp_ne_u32 vcc, 0, v1
    v_mfma_f32_16x16x32_bf16 v[144:147], v[236:239], a[148:151], v[144:147]
    ds_read_b128 v[224:227], v58 offset:27648
    v_mfma_f32_16x16x32_bf16 v[144:147], v[240:243], a[156:159], v[144:147]
    s_nop 1
    s_cbranch_vccnz L_slow_9
L_back_10:
    buffer_load_dwordx4 v65, s[12:15], s47 offen offset:1024 sc1 lds
    v_mfma_f32_16x16x32_bf16 v[140:143], v[240:243], a[152:155], v[140:143]
    ds_read_b128 v[228:231], v58 offset:28672
    v_and_b32 v88, s54, v88
    v_mfma_f32_16x16x32_bf16 v[140:143], v[236:239], a[144:147], v[140:143]
    s_waitcnt lgkmcnt(3)
    v_lshl_or_b32 v84, v88, 16, v79
    v_and_or_b32 v85, v88, s55, v79
    v_mfma_f32_16x16x32_bf16 v[132:135], v[212:215], a[160:163], v[132:135]
    ds_read_b128 v[232:235], v58 offset:29696
    v_and_b32 v89, s54, v89
    v_mfma_f32_16x16x32_bf16 v[132:135], v[216:219], a[168:171], v[132:135]
    buffer_load_dwordx4 v65, s[12:15], s47 offen offset:2048 sc1 lds
    v_mfma_f32_16x16x32_bf16 v[136:139], v[216:219], a[172:175], v[136:139]
    ds_read_b128 v[236:239], v58 offset:30720
    v_lshl_or_b32 v86, v89, 16, v79
    v_mfma_f32_16x16x32_bf16 v[136:139], v[212:215], a[164:167], v[136:139]
    s_waitcnt lgkmcnt(3)
    v_and_or_b32 v87, v89, s55, v79
    v_and_b32 v90, s54, v90
    v_mfma_f32_16x16x32_bf16 v[136:139], v[220:223], a[180:183], v[136:139]
    ds_read_b128 v[240:243], v58 offset:31744
    v_lshl_or_b32 v88, v90, 16, v79
    v_mfma_f32_16x16x32_bf16 v[136:139], v[224:227], a[188:191], v[136:139]
    buffer_load_dwordx4 v65, s[12:15], s47 offen offset:3072 sc1 lds
    v_mfma_f32_16x16x32_bf16 v[132:135], v[224:227], a[184:187], v[132:135]
    s_waitcnt vmcnt(6)
    s_barrier
    ds_read_b128 v[212:215], v58 offset:0
    v_mfma_f32_16x16x32_bf16 v[132:135], v[220:223], a[176:179], v[132:135]
    s_waitcnt lgkmcnt(3)
    v_and_or_b32 v89, v90, s55, v79
    v_and_b32 v91, s54, v91
    v_mfma_f32_16x16x32_bf16 v[140:143], v[228:231], a[160:163], v[140:143]
    s_add_u32 s47, s84, 20
    ds_read_b128 v[216:219], v58 offset:1024
    s_sub_u32 s48, s47, 28
    v_mfma_f32_16x16x32_bf16 v[140:143], v[232:235], a[168:171], v[140:143]
    s_min_u32 s47, s47, s48
    s_add_u32 m0, s85, 81920
    s_lshl_b32 s47, s47, 12
    v_mfma_f32_16x16x32_bf16 v[144:147], v[232:235], a[172:175], v[144:147]
    ds_read_b128 v[220:223], v58 offset:2048
    v_lshl_or_b32 v90, v91, 16, v79
    v_mfma_f32_16x16x32_bf16 v[144:147], v[228:231], a[164:167], v[144:147]
    s_waitcnt lgkmcnt(3)
    buffer_load_dwordx4 v65, s[12:15], s47 offen sc1 lds
    v_mfma_f32_16x16x32_bf16 v[144:147], v[236:239], a[180:183], v[144:147]
    ds_read_b128 v[224:227], v58 offset:3072
    v_and_or_b32 v91, v91, s55, v79
    v_mfma_f32_16x16x32_bf16 v[144:147], v[240:243], a[188:191], v[144:147]
    v_and_b32 v96, s54, v96
    v_lshl_or_b32 v92, v96, 16, v79
    v_mfma_f32_16x16x32_bf16 v[140:143], v[240:243], a[184:187], v[140:143]
    ds_read_b128 v[228:231], v58 offset:4096
    v_and_or_b32 v93, v96, s55, v79
    v_mfma_f32_16x16x32_bf16 v[140:143], v[236:239], a[176:179], v[140:143]
    s_waitcnt lgkmcnt(3)
    buffer_load_dwordx4 v65, s[12:15], s47 offen offset:1024 sc1 lds
    v_mfma_f32_16x16x32_bf16 v[132:135], v[212:215], a[192:195], v[132:135]
    ds_read_b128 v[232:235], v58 offset:5120
    v_and_b32 v97, s54, v97
    v_mfma_f32_16x16x32_bf16 v[132:135], v[216:219], a[200:203], v[132:135]
    v_lshl_or_b32 v94, v97, 16, v79
    v_and_or_b32 v95, v97, s55, v79
    v_mfma_f32_16x16x32_bf16 v[136:139], v[216:219], a[204:207], v[136:139]
    ds_read_b128 v[236:239], v58 offset:6144
    v_and_b32 v98, s54, v98
    v_mfma_f32_16x16x32_bf16 v[136:139], v[212:215], a[196:199], v[136:139]
    s_waitcnt lgkmcnt(3)
    buffer_load_dwordx4 v65, s[12:15], s47 offen offset:2048 sc1 lds
    v_mfma_f32_16x16x32_bf16 v[136:139], v[220:223], a[212:215], v[136:139]
    ds_read_b128 v[240:243], v58 offset:7168
    v_lshl_or_b32 v96, v98, 16, v79
    v_mfma_f32_16x16x32_bf16 v[136:139], v[224:227], a[220:223], v[136:139]
    v_and_or_b32 v97, v98, s55, v79
    v_and_b32 v99, s54, v99
    v_mfma_f32_16x16x32_bf16 v[132:135], v[224:227], a[216:219], v[132:135]
    ds_read_b128 v[212:215], v58 offset:32768
    v_lshl_or_b32 v98, v99, 16, v79
    v_mfma_f32_16x16x32_bf16 v[132:135], v[220:223], a[208:211], v[132:135]
    s_waitcnt lgkmcnt(3)
    buffer_load_dwordx4 v65, s[12:15], s47 offen offset:3072 sc1 lds
    v_mfma_f32_16x16x32_bf16 v[140:143], v[228:231], a[192:195], v[140:143]
    ds_read_b128 v[216:219], v58 offset:33792
    v_and_or_b32 v99, v99, s55, v79
    v_mfma_f32_16x16x32_bf16 v[140:143], v[232:235], a[200:203], v[140:143]
    v_fmac_f32 v116, v84, v16
    v_fmac_f32 v117, v85, v17
    v_mfma_f32_16x16x32_bf16 v[144:147], v[232:235], a[204:207], v[144:147]
    s_add_u32 s47, s84, 16
    ds_read_b128 v[220:223], v58 offset:34816
    s_sub_u32 s48, s47, 28
    v_mfma_f32_16x16x32_bf16 v[144:147], v[228:231], a[196:199], v[144:147]
    s_waitcnt lgkmcnt(3)
    s_min_u32 s47, s47, s48
    s_add_u32 m0, s85, 65536
    v_mfma_f32_16x16x32_bf16 v[144:147], v[236:239], a[212:215], v[144:147]
    s_lshl_b32 s47, s47, 12
    ds_read_b128 v[224:227], v58 offset:35840
    v_fmac_f32 v118, v86, v18
    v_mfma_f32_16x16x32_bf16 v[144:147], v[240:243], a[220:223], v[144:147]
    buffer_load_dwordx4 v65, s[12:15], s47 offen sc1 lds
    v_mfma_f32_16x16x32_bf16 v[140:143], v[240:243], a[216:219], v[140:143]
    ds_read_b128 v[228:231], v58 offset:36864
    v_fmac_f32 v119, v87, v19
    v_mfma_f32_16x16x32_bf16 v[140:143], v[236:239], a[208:211], v[140:143]
    s_waitcnt lgkmcnt(3)
    v_fmac_f32 v124, v92, v20
    v_fmac_f32 v125, v93, v21
    v_mfma_f32_16x16x32_bf16 v[132:135], v[212:215], a[224:227], v[132:135]
    ds_read_b128 v[232:235], v58 offset:37888
    v_fmac_f32 v126, v94, v22
    v_mfma_f32_16x16x32_bf16 v[132:135], v[216:219], a[232:235], v[132:135]
    buffer_load_dwordx4 v65, s[12:15], s47 offen offset:1024 sc1 lds
    v_mfma_f32_16x16x32_bf16 v[136:139], v[216:219], a[236:239], v[136:139]
    ds_read_b128 v[236:239], v58 offset:38912
    v_fmac_f32 v127, v95, v23
    v_mfma_f32_16x16x32_bf16 v[136:139], v[212:215], a[228:231], v[136:139]
    s_waitcnt lgkmcnt(3)
    v_cvt_pk_bf16_f32 v244, v116, v117
    v_cvt_pk_bf16_f32 v245, v118, v119
    v_mfma_f32_16x16x32_bf16 v[136:139], v[220:223], a[244:247], v[136:139]
    ds_read_b128 v[240:243], v58 offset:39936
    s_waitcnt vmcnt(10)
    v_mfma_f32_16x16x32_bf16 v[136:139], v[224:227], a[252:255], v[136:139]
    s_barrier
    buffer_load_dwordx4 v65, s[12:15], s47 offen offset:2048 sc1 lds
    v_mfma_f32_16x16x32_bf16 v[132:135], v[224:227], a[248:251], v[132:135]
    ds_read_b128 v[180:183], v67 offset:3584
    v_cvt_pk_bf16_f32 v246, v124, v125
    v_mfma_f32_16x16x32_bf16 v[132:135], v[220:223], a[240:243], v[132:135]
    s_waitcnt lgkmcnt(3)
    ds_read2_b32 v[148:149], v252 offset0:0 offset1:1
    v_cvt_pk_bf16_f32 v247, v126, v127
    v_mfma_f32_16x16x32_bf16 v[140:143], v[228:231], a[224:227], v[140:143]
    s_add_u32 s83, s79, 0
    buffer_load_dwordx4 v65, s[12:15], s47 offen offset:3072 sc1 lds
    v_mfma_f32_16x16x32_bf16 v[140:143], v[232:235], a[232:235], v[140:143]
    buffer_store_dwordx4 v[244:247], v58, s[12:15], s83 offen sc1
    v_mfma_f32_16x16x32_bf16 v[144:147], v[232:235], a[236:239], v[144:147]
    ds_read2_b32 v[150:151], v252 offset0:2 offset1:3
    v_fmac_f32 v120, v88, v32
    v_mfma_f32_16x16x32_bf16 v[144:147], v[228:231], a[228:231], v[144:147]
    s_waitcnt lgkmcnt(3)
    ds_read_b128 v[184:187], v67 offset:3072
    v_fmac_f32 v121, v89, v33
    v_mfma_f32_16x16x32_bf16 v[144:147], v[236:239], a[244:247], v[144:147]
    ds_read2_b32 v[152:153], v252 offset0:128 offset1:129
    v_fmac_f32 v122, v90, v34
    v_mfma_f32_16x16x32_bf16 v[144:147], v[240:243], a[252:255], v[144:147]
    ds_read2_b32 v[154:155], v252 offset0:130 offset1:131
    v_fmac_f32 v123, v91, v35
    v_mfma_f32_16x16x32_bf16 v[140:143], v[240:243], a[248:251], v[140:143]
    v_fmac_f32 v128, v96, v36
    v_fmac_f32 v129, v97, v37
    v_mfma_f32_16x16x32_bf16 v[140:143], v[236:239], a[240:243], v[140:143]
    v_fmac_f32 v130, v98, v38
    v_fmac_f32 v131, v99, v39
    v_cvt_pk_bf16_f32 v248, v120, v121
    v_cvt_pk_bf16_f32 v249, v122, v123
    v_cvt_pk_bf16_f32 v250, v128, v129
    v_cvt_pk_bf16_f32 v251, v130, v131
    s_add_u32 s83, s79, 28672
    buffer_store_dwordx4 v[248:251], v58, s[12:15], s83 offen sc1
    v_xor_b32 v1, v104, v72
    v_bitop3_b32 v1, v1, v105, v73 bitop3:0xf6
    v_bitop3_b32 v1, v1, v106, v74 bitop3:0xf6
    v_bitop3_b32 v1, v1, v107, v75 bitop3:0xf6
    v_bitop3_b32 v1, v1, v112, v72 bitop3:0xf6
    v_bitop3_b32 v1, v1, v113, v73 bitop3:0xf6
    v_bitop3_b32 v1, v1, v114, v74 bitop3:0xf6
    v_bitop3_b32 v1, v1, v115, v75 bitop3:0xf6
    v_and_b32 v1, 0x00010001, v1
    v_cmp_ne_u32 vcc, 0, v1
    s_nop 4
    s_cbranch_vccnz L_slow_11
L_back_12:
    v_and_b32 v104, s54, v104
    v_lshl_or_b32 v100, v104, 16, v79
    v_and_or_b32 v101, v104, s55, v79
    v_and_b32 v105, s54, v105
    v_lshl_or_b32 v102, v105, 16, v79
    v_and_or_b32 v103, v105, s55, v79
    v_and_b32 v106, s54, v106
    v_lshl_or_b32 v104, v106, 16, v79
    v_and_or_b32 v105, v106, s55, v79
    v_and_b32 v107, s54, v107
    v_lshl_or_b32 v106, v107, 16, v79
    v_and_or_b32 v107, v107, s55, v79
    v_and_b32 v112, s54, v112
    v_lshl_or_b32 v108, v112, 16, v79
    v_and_or_b32 v109, v112, s55, v79
    v_and_b32 v113, s54, v113
    v_lshl_or_b32 v110, v113, 16, v79
    v_and_or_b32 v111, v113, s55, v79
    v_and_b32 v114, s54, v114
    v_lshl_or_b32 v112, v114, 16, v79
    v_and_or_b32 v113, v114, s55, v79
    v_and_b32 v115, s54, v115
    v_lshl_or_b32 v114, v115, 16, v79
    v_and_or_b32 v115, v115, s55, v79
    v_mul_f32 v100, v100, v24
    v_mul_f32 v101, v101, v25
    v_mul_f32 v102, v102, v26
    v_mul_f32 v103, v103, v27
    v_mul_f32 v104, v104, v40
    v_mul_f32 v105, v105, v41
    v_mul_f32 v106, v106, v42
    v_mul_f32 v107, v107, v43
    v_mul_f32 v108, v108, v28
    v_mul_f32 v109, v109, v29
    v_mul_f32 v110, v110, v30
    v_mul_f32 v111, v111, v31
    v_mul_f32 v112, v112, v44
    v_mul_f32 v113, v113, v45
    v_mul_f32 v114, v114, v46
    v_mul_f32 v115, v115, v47
    v_pk_fma_f32 v[100:101], v[132:133], v[24:25], v[100:101]
    v_pk_fma_f32 v[102:103], v[134:135], v[26:27], v[102:103]
    v_pk_fma_f32 v[108:109], v[140:141], v[28:29], v[108:109]
    v_pk_fma_f32 v[110:111], v[142:143], v[30:31], v[110:111]
    v_cvt_pk_bf16_f32 v244, v100, v101
    v_cvt_pk_bf16_f32 v245, v102, v103
    v_cvt_pk_bf16_f32 v246, v108, v109
    v_cvt_pk_bf16_f32 v247, v110, v111
    s_add_u32 s83, s79, 1024
    buffer_store_dwordx4 v[244:247], v58, s[12:15], s83 offen sc1
    v_pk_fma_f32 v[104:105], v[136:137], v[40:41], v[104:105]
    v_pk_fma_f32 v[106:107], v[138:139], v[42:43], v[106:107]
    v_pk_fma_f32 v[112:113], v[144:145], v[44:45], v[112:113]
    v_pk_fma_f32 v[114:115], v[146:147], v[46:47], v[114:115]
    v_cvt_pk_bf16_f32 v248, v104, v105
    v_cvt_pk_bf16_f32 v249, v106, v107
    v_cvt_pk_bf16_f32 v250, v112, v113
    v_cvt_pk_bf16_f32 v251, v114, v115
    s_add_u32 s83, s79, 29696
    buffer_store_dwordx4 v[248:251], v58, s[12:15], s83 offen sc1
    s_waitcnt lgkmcnt(3)
    v_mfma_f32_16x16x32_bf16 v[16:19], v[148:151], v[180:183], 0
    s_waitcnt lgkmcnt(0)
    ds_read_b128 v[188:191], v67 offset:2560
    v_add_u32 v71, 65536, v58
    v_mfma_f32_16x16x32_bf16 v[20:23], v[148:151], v[184:187], 0
    ds_read2_b32 v[156:157], v253 offset0:0 offset1:1
L_pad5:
    s_cbranch_execz L_warm
    v_min_u32 v2, 13, v0
    v_mfma_f32_16x16x32_bf16 v[20:23], v[152:155], v[180:183], v[20:23]
    s_barrier
    ds_read2_b32 v[158:159], v253 offset0:2 offset1:3
    s_add_u32 s47, s84, 12
    v_mfma_f32_16x16x32_bf16 v[24:27], v[152:155], v[184:187], 0
    s_waitcnt lgkmcnt(0)
    ds_read_b128 v[192:195], v67 offset:2048
    s_sub_u32 s48, s47, 28
    v_mfma_f32_16x16x32_bf16 v[24:27], v[148:151], v[188:191], v[24:27]
    s_min_u32 s47, s47, s48
    ds_read2_b32 v[160:161], v253 offset0:128 offset1:129
    s_add_u32 m0, s85, 49152
    v_mfma_f32_16x16x32_bf16 v[28:31], v[152:155], v[188:191], 0
    s_lshl_b32 s47, s47, 12
    buffer_load_dwordx4 v65, s[12:15], s47 offen sc1 lds
    v_mfma_f32_16x16x32_bf16 v[24:27], v[156:159], v[180:183], v[24:27]
    ds_read2_b32 v[162:163], v253 offset0:130 offset1:131
    v_lshrrev_b32 v3, 1, v2
    v_mfma_f32_16x16x32_bf16 v[28:31], v[156:159], v[184:187], v[28:31]
    ds_read_b128 v[196:199], v67 offset:1536
    v_and_b32 v2, 1, v2
    v_mfma_f32_16x16x32_bf16 v[32:35], v[156:159], v[188:191], 0
    s_waitcnt lgkmcnt(1)
    buffer_load_dwordx4 v65, s[12:15], s47 offen offset:1024 sc1 lds
    v_mfma_f32_16x16x32_bf16 v[28:31], v[148:151], v[192:195], v[28:31]
    ds_read2_b32 v[164:165], v254 offset0:0 offset1:1
    v_lshlrev_b32 v2, 7, v2
    v_mfma_f32_16x16x32_bf16 v[32:35], v[152:155], v[192:195], v[32:35]
    ds_read2_b32 v[166:167], v254 offset0:2 offset1:3
    v_lshl_add_u32 v80, v3, 12, v2
    v_mfma_f32_16x16x32_bf16 v[36:39], v[156:159], v[192:195], 0
    s_lshl_b32 s60, s39, 8
    buffer_load_dwordx4 v65, s[12:15], s47 offen offset:2048 sc1 lds
    v_mfma_f32_16x16x32_bf16 v[28:31], v[160:163], v[180:183], v[28:31]
    ds_read_b128 v[200:203], v67 offset:1024
    v_lshrrev_b32 v1, 5, v0
    v_mfma_f32_16x16x32_bf16 v[32:35], v[160:163], v[184:187], v[32:35]
    ds_read2_b32 v[168:169], v254 offset0:128 offset1:129
    v_lshl_add_u32 v1, v1, 7, v58
    v_mfma_f32_16x16x32_bf16 v[36:39], v[160:163], v[188:191], v[36:39]
    s_mul_i32 s45, s36, 10240
    buffer_load_dwordx4 v65, s[12:15], s47 offen offset:3072 sc1 lds
    v_mfma_f32_16x16x32_bf16 v[40:43], v[160:163], v[192:195], 0
    s_waitcnt lgkmcnt(2)
    ds_read2_b32 v[170:171], v254 offset0:130 offset1:131
    s_add_u32 s45, s45, 114688
    v_mfma_f32_16x16x32_bf16 v[32:35], v[148:151], v[196:199], v[32:35]
    ds_read_b128 v[204:207], v67 offset:512
    v_add_u32 v56, s45, v1
    v_mfma_f32_16x16x32_bf16 v[36:39], v[152:155], v[196:199], v[36:39]
    s_add_u32 s47, s84, 8
    ds_read2_b32 v[172:173], v255 offset0:0 offset1:1
    s_sub_u32 s48, s47, 28
    v_mfma_f32_16x16x32_bf16 v[40:43], v[156:159], v[196:199], v[40:43]
    s_min_u32 s47, s47, s48
    ds_read2_b32 v[174:175], v255 offset0:2 offset1:3
    s_add_u32 m0, s85, 32768
    v_mfma_f32_16x16x32_bf16 v[44:47], v[160:163], v[196:199], 0
    s_lshl_b32 s47, s47, 12
    buffer_load_dwordx4 v65, s[12:15], s47 offen sc1 lds
    v_mfma_f32_16x16x32_bf16 v[32:35], v[164:167], v[180:183], v[32:35]
    ds_read_b128 v[208:211], v67 offset:0
    v_and_b32 v2, 1, v0
    v_mfma_f32_16x16x32_bf16 v[36:39], v[164:167], v[184:187], v[36:39]
    ds_read2_b32 v[176:177], v255 offset0:128 offset1:129
    v_bfe_u32 v3, v0, 2, 1
    v_mfma_f32_16x16x32_bf16 v[40:43], v[164:167], v[188:191], v[40:43]
    buffer_load_dwordx4 v65, s[12:15], s47 offen offset:1024 sc1 lds
    v_mfma_f32_16x16x32_bf16 v[44:47], v[164:167], v[192:195], v[44:47]
    s_waitcnt lgkmcnt(5)
    ds_read2_b32 v[178:179], v255 offset0:130 offset1:131
    v_mul_u32_u24 v1, 640, v2
    v_mfma_f32_16x16x32_bf16 v[36:39], v[148:151], v[200:203], v[36:39]
    ds_read_b128 v[116:119], v67 offset:3648
    v_lshl_add_u32 v1, v3, 8, v1
    v_mfma_f32_16x16x32_bf16 v[40:43], v[152:155], v[200:203], v[40:43]
    buffer_load_dwordx4 v65, s[12:15], s47 offen offset:2048 sc1 lds
    v_mfma_f32_16x16x32_bf16 v[44:47], v[156:159], v[200:203], v[44:47]
    ds_read2_b32 v[84:85], v252 offset0:16 offset1:17
    v_lshl_add_u32 v2, v2, 1, v3
    v_mfma_f32_16x16x32_bf16 v[36:39], v[168:171], v[180:183], v[36:39]
    ds_read2_b32 v[86:87], v252 offset0:18 offset1:19
    v_lshl_add_u32 v1, v63, 5, v1
    v_mfma_f32_16x16x32_bf16 v[40:43], v[168:171], v[184:187], v[40:43]
    buffer_load_dwordx4 v65, s[12:15], s47 offen offset:3072 sc1 lds
    v_mfma_f32_16x16x32_bf16 v[44:47], v[168:171], v[188:191], v[44:47]
    s_waitcnt lgkmcnt(6)
    ds_read_b128 v[120:123], v67 offset:3136
    v_bfe_u32 v3, v0, 1, 1
    v_mfma_f32_16x16x32_bf16 v[40:43], v[148:151], v[204:207], v[40:43]
    ds_read2_b32 v[88:89], v252 offset0:144 offset1:145
    v_lshl_add_u32 v1, v3, 4, v1
    v_mfma_f32_16x16x32_bf16 v[44:47], v[152:155], v[204:207], v[44:47]
    s_add_u32 s47, s84, 4
    ds_read2_b32 v[90:91], v252 offset0:146 offset1:147
    s_sub_u32 s48, s47, 28
    v_mfma_f32_16x16x32_bf16 v[40:43], v[172:175], v[180:183], v[40:43]
    s_min_u32 s47, s47, s48
    ds_read_b128 v[124:127], v67 offset:2624
    s_add_u32 m0, s85, 16384
    v_mfma_f32_16x16x32_bf16 v[44:47], v[172:175], v[184:187], v[44:47]
    s_waitcnt lgkmcnt(7)
    ds_read2_b32 v[92:93], v253 offset0:16 offset1:17
    s_lshl_b32 s47, s47, 12
    v_mfma_f32_16x16x32_bf16 v[44:47], v[148:151], v[208:211], v[44:47]
    s_mul_i32 s45, s36, 2560
    buffer_load_dwordx4 v65, s[12:15], s47 offen sc1 lds
    v_mfma_f32_16x16x32_bf16 v[44:47], v[176:179], v[180:183], v[44:47]
    s_waitcnt lgkmcnt(5)
    ds_read2_b32 v[94:95], v253 offset0:18 offset1:19
    s_add_u32 s45, s45, 114688
    v_mfma_f32_16x16x32_bf16 v[16:19], v[84:87], v[116:119], v[16:19]
    s_waitcnt lgkmcnt(3)
    ds_read_b128 v[128:131], v67 offset:2112
    v_add_u32 v78, s45, v1
    v_mfma_f32_16x16x32_bf16 v[20:23], v[84:87], v[120:123], v[20:23]
    buffer_load_dwordx4 v65, s[12:15], s47 offen offset:1024 sc1 lds
    v_mfma_f32_16x16x32_bf16 v[20:23], v[88:91], v[116:119], v[20:23]
    s_waitcnt lgkmcnt(1)
    ds_read2_b32 v[96:97], v253 offset0:144 offset1:145
    v_lshl_add_u32 v2, v3, 2, v2
    v_mfma_f32_16x16x32_bf16 v[24:27], v[84:87], v[124:127], v[24:27]
    ds_read2_b32 v[98:99], v253 offset0:146 offset1:147
    v_lshl_add_u32 v2, v63, 3, v2
    v_mfma_f32_16x16x32_bf16 v[24:27], v[88:91], v[120:123], v[24:27]
    buffer_load_dwordx4 v65, s[12:15], s47 offen offset:2048 sc1 lds
    v_mfma_f32_16x16x32_bf16 v[24:27], v[92:95], v[116:119], v[24:27]
    s_waitcnt lgkmcnt(0)
    ds_read_b128 v[132:135], v67 offset:1600
    v_lshlrev_b32 v2, 3, v2
    v_mfma_f32_16x16x32_bf16 v[28:31], v[84:87], v[128:131], v[28:31]
    s_lshl_b32 s45, s36, 10
    ds_read2_b32 v[100:101], v254 offset0:16 offset1:17
    s_sub_u32 s45, 134904, s45
    v_mfma_f32_16x16x32_bf16 v[28:31], v[88:91], v[124:127], v[28:31]
    buffer_load_dwordx4 v65, s[12:15], s47 offen offset:3072 sc1 lds
    v_mfma_f32_16x16x32_bf16 v[28:31], v[92:95], v[120:123], v[28:31]
    s_waitcnt vmcnt(12)
    ds_read2_b32 v[102:103], v254 offset0:18 offset1:19
    s_barrier
    v_mfma_f32_16x16x32_bf16 v[28:31], v[96:99], v[116:119], v[28:31]
    s_waitcnt lgkmcnt(0)
    ds_read_b128 v[136:139], v67 offset:1088
    s_mov_b32 s52, 98304
    v_mfma_f32_16x16x32_bf16 v[32:35], v[84:87], v[132:135], v[32:35]
    s_add_u32 s47, s84, 0
    buffer_store_dwordx4 v[4:7], v59, s[12:15], s52 offen sc1
    v_mfma_f32_16x16x32_bf16 v[32:35], v[88:91], v[128:131], v[32:35]
    s_sub_u32 s48, s47, 28
    ds_read2_b32 v[104:105], v254 offset0:144 offset1:145
    s_min_u32 s47, s47, s48
    v_mfma_f32_16x16x32_bf16 v[32:35], v[92:95], v[124:127], v[32:35]
    s_mov_b32 m0, s85
    ds_read2_b32 v[106:107], v254 offset0:146 offset1:147
    s_lshl_b32 s47, s47, 12
    v_mfma_f32_16x16x32_bf16 v[32:35], v[96:99], v[120:123], v[32:35]
    buffer_load_dwordx4 v65, s[12:15], s47 offen sc1 lds
    v_mfma_f32_16x16x32_bf16 v[32:35], v[100:103], v[116:119], v[32:35]
    s_waitcnt lgkmcnt(0)
    ds_read_b128 v[140:143], v67 offset:576
    v_sub_u32 v57, s45, v2
    v_mfma_f32_16x16x32_bf16 v[36:39], v[84:87], v[136:139], v[36:39]
    ds_read2_b32 v[108:109], v255 offset0:16 offset1:17
    v_and_b32 v1, 12, v0
    v_mfma_f32_16x16x32_bf16 v[36:39], v[88:91], v[132:135], v[36:39]
    buffer_load_dwordx4 v65, s[12:15], s47 offen offset:1024 sc1 lds
    v_mfma_f32_16x16x32_bf16 v[36:39], v[92:95], v[128:131], v[36:39]
    ds_read2_b32 v[110:111], v255 offset0:18 offset1:19
    v_and_b32 v2, 15, v0
    v_mfma_f32_16x16x32_bf16 v[36:39], v[96:99], v[124:127], v[36:39]
    ds_read_b128 v[144:147], v67 offset:64
    v_add_u32 v1, v1, v2
    v_mfma_f32_16x16x32_bf16 v[36:39], v[100:103], v[120:123], v[36:39]
    buffer_load_dwordx4 v65, s[12:15], s47 offen offset:2048 sc1 lds
    v_mfma_f32_16x16x32_bf16 v[36:39], v[104:107], v[116:119], v[36:39]
    s_waitcnt lgkmcnt(1)
    ds_read2_b32 v[112:113], v255 offset0:144 offset1:145
    v_lshrrev_b32 v1, v1, v4
    v_mfma_f32_16x16x32_bf16 v[40:43], v[84:87], v[140:143], v[40:43]
    ds_read2_b32 v[114:115], v255 offset0:146 offset1:147
    v_and_b32 v1, 0x11, v1
    v_mfma_f32_16x16x32_bf16 v[40:43], v[88:91], v[136:139], v[40:43]
    buffer_load_dwordx4 v65, s[12:15], s47 offen offset:3072 sc1 lds
    v_mfma_f32_16x16x32_bf16 v[40:43], v[92:95], v[132:135], v[40:43]
    ds_read_b128 v[180:183], v67 offset:3712
    v_lshl_or_b32 v62, v1, 12, v1
    v_mfma_f32_16x16x32_bf16 v[40:43], v[96:99], v[128:131], v[40:43]
    ds_read2_b32 v[148:149], v252 offset0:32 offset1:33
    v_lshlrev_b32 v76, 16, v60
    v_mfma_f32_16x16x32_bf16 v[40:43], v[100:103], v[124:127], v[40:43]
    ds_read2_b32 v[150:151], v252 offset0:34 offset1:35
    v_and_b32 v77, 0xffff0000, v60
    v_mfma_f32_16x16x32_bf16 v[40:43], v[104:107], v[120:123], v[40:43]
    ds_read_b128 v[184:187], v67 offset:3200
    v_and_b32 v1, 0x70, v58
    v_mfma_f32_16x16x32_bf16 v[40:43], v[108:111], v[116:119], v[40:43]
    s_waitcnt lgkmcnt(4)
    ds_read2_b32 v[152:153], v252 offset0:160 offset1:161
    v_lshl_add_u32 v66, v63, 12, v1
    v_mfma_f32_16x16x32_bf16 v[44:47], v[84:87], v[144:147], v[44:47]
    s_lshl2_add_u32 s45, s37, s36
    ds_read2_b32 v[154:155], v252 offset0:162 offset1:163
    s_lshl_b32 s45, s45, 16
    v_mfma_f32_16x16x32_bf16 v[44:47], v[88:91], v[140:143], v[44:47]
    s_lshl_b32 s46, s41, 7
    ds_read_b128 v[188:191], v67 offset:2688
    s_add_u32 s45, s45, s46
    v_mfma_f32_16x16x32_bf16 v[44:47], v[92:95], v[136:139], v[44:47]
    s_add_u32 s58, s45, 3145728
    ds_read2_b32 v[156:157], v253 offset0:32 offset1:33
    s_lshl2_add_u32 s61, s39, s36
    v_mfma_f32_16x16x32_bf16 v[44:47], v[96:99], v[132:135], v[44:47]
    s_lshl1_add_u32 s45, s61, s38
    ds_read2_b32 v[158:159], v253 offset0:34 offset1:35
    s_mul_i32 s45, s45, 28672
    v_mfma_f32_16x16x32_bf16 v[44:47], v[100:103], v[128:131], v[44:47]
    s_add_u32 s45, s45, 11534336
    ds_read_b128 v[192:195], v67 offset:2176
    s_lshl_b32 s46, s88, 10
    v_mfma_f32_16x16x32_bf16 v[44:47], v[104:107], v[124:127], v[44:47]
    s_add_u32 s79, s45, s46
    ds_read2_b32 v[160:161], v253 offset0:160 offset1:161
    s_sub_u32 s80, s45, s46
    v_mfma_f32_16x16x32_bf16 v[44:47], v[108:111], v[120:123], v[44:47]
    ds_read2_b32 v[162:163], v253 offset0:162 offset1:163
    v_and_b32 v1, 15, v0
    v_mfma_f32_16x16x32_bf16 v[44:47], v[112:115], v[116:119], v[44:47]
    s_waitcnt lgkmcnt(9)
    ds_read_b128 v[196:199], v67 offset:1664
    v_lshlrev_b32 v1, 2, v1
    v_mfma_f32_16x16x32_bf16 v[16:19], v[148:151], v[180:183], v[16:19]
    s_waitcnt lgkmcnt(7)
    ds_read2_b32 v[164:165], v254 offset0:32 offset1:33
    v_lshrrev_b32 v2, 4, v0
    v_mfma_f32_16x16x32_bf16 v[20:23], v[148:151], v[184:187], v[20:23]
    ds_read2_b32 v[166:167], v254 offset0:34 offset1:35
    v_lshl_add_u32 v68, v2, 8, v1
    v_mfma_f32_16x16x32_bf16 v[20:23], v[152:155], v[180:183], v[20:23]
    s_waitcnt lgkmcnt(6)
    ds_read_b128 v[200:203], v67 offset:1152
    s_lshl_b32 s45, s37, 18
    v_mfma_f32_16x16x32_bf16 v[24:27], v[148:151], v[188:191], v[24:27]
    s_lshl_b32 s46, s61, 12
    ds_read2_b32 v[168:169], v254 offset0:160 offset1:161
    s_add_u32 s45, s45, s46
    v_mfma_f32_16x16x32_bf16 v[24:27], v[152:155], v[184:187], v[24:27]
    s_lshl_b32 s46, s38, 6
    ds_read2_b32 v[170:171], v254 offset0:162 offset1:163
    s_add_u32 s45, s45, s46
    v_mfma_f32_16x16x32_bf16 v[24:27], v[156:159], v[180:183], v[24:27]
    s_waitcnt lgkmcnt(6)
    ds_read_b128 v[204:207], v67 offset:640
    s_add_u32 s59, s45, 3145728
    v_mfma_f32_16x16x32_bf16 v[28:31], v[148:151], v[192:195], v[28:31]
    ds_read2_b32 v[172:173], v255 offset0:32 offset1:33
    v_and_b32 v1, 12, v0
    v_mfma_f32_16x16x32_bf16 v[28:31], v[152:155], v[188:191], v[28:31]
    ds_read2_b32 v[174:175], v255 offset0:34 offset1:35
    v_and_b32 v3, 15, v0
    v_mfma_f32_16x16x32_bf16 v[28:31], v[156:159], v[184:187], v[28:31]
    s_lshl_b32 s45, s61, 5
    ds_read_b128 v[208:211], v67 offset:128
    s_lshl2_add_u32 s45, s38, s45
    v_mfma_f32_16x16x32_bf16 v[28:31], v[160:163], v[180:183], v[28:31]
    s_waitcnt lgkmcnt(7)
    ds_read2_b32 v[176:177], v255 offset0:160 offset1:161
    v_add3_u32 v1, v1, v3, s45
    v_mfma_f32_16x16x32_bf16 v[32:35], v[148:151], v[196:199], v[32:35]
    ds_read2_b32 v[178:179], v255 offset0:162 offset1:163
    v_lshlrev_b32 v70, 3, v1
    v_mfma_f32_16x16x32_bf16 v[32:35], v[152:155], v[192:195], v[32:35]
    ds_read_b128 v[116:119], v67 offset:3776
    v_mul_u32_u24 v1, 896, v1
    v_mfma_f32_16x16x32_bf16 v[32:35], v[156:159], v[188:191], v[32:35]
    ds_read2_b32 v[84:85], v252 offset0:48 offset1:49
    v_and_b32 v3, 1, v2
    v_mfma_f32_16x16x32_bf16 v[32:35], v[160:163], v[184:187], v[32:35]
    ds_read2_b32 v[86:87], v252 offset0:50 offset1:51
    v_lshl_add_u32 v1, v3, 5, v1
    v_mfma_f32_16x16x32_bf16 v[32:35], v[164:167], v[180:183], v[32:35]
    s_waitcnt lgkmcnt(9)
    ds_read_b128 v[120:123], v67 offset:3264
    v_lshrrev_b32 v3, 1, v2
    v_mfma_f32_16x16x32_bf16 v[36:39], v[148:151], v[200:203], v[36:39]
    ds_read2_b32 v[88:89], v252 offset0:176 offset1:177
    v_lshl_add_u32 v1, v3, 4, v1
    v_mfma_f32_16x16x32_bf16 v[36:39], v[152:155], v[196:199], v[36:39]
    s_lshl_b32 s46, s37, 7
    ds_read2_b32 v[90:91], v252 offset0:178 offset1:179
    v_add_u32 v69, s46, v1
    v_mfma_f32_16x16x32_bf16 v[36:39], v[156:159], v[192:195], v[36:39]
    ds_read_b128 v[124:127], v67 offset:2752
    v_mfma_f32_16x16x32_bf16 v[36:39], v[160:163], v[188:191], v[36:39]
    ds_read2_b32 v[92:93], v253 offset0:48 offset1:49
    v_mfma_f32_16x16x32_bf16 v[36:39], v[164:167], v[184:187], v[36:39]
    ds_read2_b32 v[94:95], v253 offset0:50 offset1:51
    v_mfma_f32_16x16x32_bf16 v[36:39], v[168:171], v[180:183], v[36:39]
    s_waitcnt lgkmcnt(12)
    ds_read_b128 v[128:131], v67 offset:2240
    v_mfma_f32_16x16x32_bf16 v[40:43], v[148:151], v[204:207], v[40:43]
    ds_read2_b32 v[96:97], v253 offset0:176 offset1:177
    v_mfma_f32_16x16x32_bf16 v[40:43], v[152:155], v[200:203], v[40:43]
    ds_read2_b32 v[98:99], v253 offset0:178 offset1:179
    v_mfma_f32_16x16x32_bf16 v[40:43], v[156:159], v[196:199], v[40:43]
    ds_read_b128 v[132:135], v67 offset:1728
    v_mfma_f32_16x16x32_bf16 v[40:43], v[160:163], v[192:195], v[40:43]
    ds_read2_b32 v[100:101], v254 offset0:48 offset1:49
    v_mfma_f32_16x16x32_bf16 v[40:43], v[164:167], v[188:191], v[40:43]
    ds_read2_b32 v[102:103], v254 offset0:50 offset1:51
    v_mfma_f32_16x16x32_bf16 v[40:43], v[168:171], v[184:187], v[40:43]
    ds_read_b128 v[136:139], v67 offset:1216
    v_mfma_f32_16x16x32_bf16 v[40:43], v[172:175], v[180:183], v[40:43]
    s_waitcnt lgkmcnt(15)
    ds_read2_b32 v[104:105], v254 offset0:176 offset1:177
    v_mfma_f32_16x16x32_bf16 v[44:47], v[148:151], v[208:211], v[44:47]
    ds_read2_b32 v[106:107], v254 offset0:178 offset1:179
    v_mfma_f32_16x16x32_bf16 v[44:47], v[152:155], v[204:207], v[44:47]
    ds_read_b128 v[140:143], v67 offset:704
    v_mfma_f32_16x16x32_bf16 v[44:47], v[156:159], v[200:203], v[44:47]
    ds_read2_b32 v[108:109], v255 offset0:48 offset1:49
    v_mfma_f32_16x16x32_bf16 v[44:47], v[160:163], v[196:199], v[44:47]
    ds_read2_b32 v[110:111], v255 offset0:50 offset1:51
    v_mfma_f32_16x16x32_bf16 v[44:47], v[164:167], v[192:195], v[44:47]
    ds_read_b128 v[144:147], v67 offset:192
    v_mfma_f32_16x16x32_bf16 v[44:47], v[168:171], v[188:191], v[44:47]
    ds_read2_b32 v[112:113], v255 offset0:176 offset1:177
    v_mfma_f32_16x16x32_bf16 v[44:47], v[172:175], v[184:187], v[44:47]
    ds_read2_b32 v[114:115], v255 offset0:178 offset1:179
    v_mfma_f32_16x16x32_bf16 v[44:47], v[176:179], v[180:183], v[44:47]
    s_waitcnt lgkmcnt(15)
    ds_read_b64 v[48:49], v57 offset:512
    v_mfma_f32_16x16x32_bf16 v[16:19], v[84:87], v[116:119], v[16:19]
    ds_read_b64 v[50:51], v57 offset:5120
    v_mfma_f32_16x16x32_bf16 v[20:23], v[84:87], v[120:123], v[20:23]
    ds_read_b64 v[52:53], v57 offset:0
    v_mfma_f32_16x16x32_bf16 v[20:23], v[88:91], v[116:119], v[20:23]
    ds_read_b64 v[54:55], v57 offset:4608
    s_waitcnt lgkmcnt(0)
    v_mfma_f32_16x16x32_bf16 v[24:27], v[84:87], v[124:127], v[24:27]
    v_and_b32 v148, 0xffff0000, v49
    v_lshlrev_b32 v149, 16, v49
    v_mfma_f32_16x16x32_bf16 v[24:27], v[88:91], v[120:123], v[24:27]
    v_and_b32 v150, 0xffff0000, v48
    v_lshlrev_b32 v151, 16, v48
    v_mfma_f32_16x16x32_bf16 v[24:27], v[92:95], v[116:119], v[24:27]
    v_and_b32 v152, 0xffff0000, v51
    v_lshlrev_b32 v153, 16, v51
    v_mfma_f32_16x16x32_bf16 v[28:31], v[84:87], v[128:131], v[28:31]
    v_and_b32 v154, 0xffff0000, v50
    v_lshlrev_b32 v155, 16, v50
    v_mfma_f32_16x16x32_bf16 v[28:31], v[88:91], v[124:127], v[28:31]
    s_barrier
    v_and_b32 v156, 0xffff0000, v53
    v_mfma_f32_16x16x32_bf16 v[28:31], v[92:95], v[120:123], v[28:31]
    ds_write_b128 v56, v[16:19] offset:0
    v_mfma_f32_16x16x32_bf16 v[28:31], v[96:99], v[116:119], v[28:31]
    v_lshlrev_b32 v157, 16, v53
    v_and_b32 v158, 0xffff0000, v52
    v_mfma_f32_16x16x32_bf16 v[32:35], v[84:87], v[132:135], v[32:35]
    v_lshlrev_b32 v159, 16, v52
    v_and_b32 v160, 0xffff0000, v55
    v_mfma_f32_16x16x32_bf16 v[32:35], v[88:91], v[128:131], v[32:35]
    v_lshlrev_b32 v161, 16, v55
    v_and_b32 v162, 0xffff0000, v54
    v_mfma_f32_16x16x32_bf16 v[32:35], v[92:95], v[124:127], v[32:35]
    ds_write_b128 v56, v[20:23] offset:1280
    v_mfma_f32_16x16x32_bf16 v[32:35], v[96:99], v[120:123], v[32:35]
    v_lshlrev_b32 v163, 16, v54
    v_mul_f32 v148, v76, v148
    v_mfma_f32_16x16x32_bf16 v[32:35], v[100:103], v[116:119], v[32:35]
    v_mul_f32 v149, v76, v149
    v_mul_f32 v150, v76, v150
    v_mfma_f32_16x16x32_bf16 v[36:39], v[84:87], v[136:139], v[36:39]
    v_mul_f32 v151, v76, v151
    v_mul_f32 v152, v77, v152
    v_mfma_f32_16x16x32_bf16 v[36:39], v[88:91], v[132:135], v[36:39]
    ds_write_b128 v56, v[24:27] offset:2560
    v_mfma_f32_16x16x32_bf16 v[36:39], v[92:95], v[128:131], v[36:39]
    v_mul_f32 v153, v77, v153
    v_mul_f32 v154, v77, v154
    v_mfma_f32_16x16x32_bf16 v[36:39], v[96:99], v[124:127], v[36:39]
    v_mul_f32 v155, v77, v155
    v_mul_f32 v156, v76, v156
    v_mfma_f32_16x16x32_bf16 v[36:39], v[100:103], v[120:123], v[36:39]
    v_mul_f32 v157, v76, v157
    v_mul_f32 v158, v76, v158
    v_mfma_f32_16x16x32_bf16 v[36:39], v[104:107], v[116:119], v[36:39]
    ds_write_b128 v56, v[28:31] offset:3840
    v_mfma_f32_16x16x32_bf16 v[40:43], v[84:87], v[140:143], v[40:43]
    v_mul_f32 v159, v76, v159
    v_mul_f32 v160, v77, v160
    v_mfma_f32_16x16x32_bf16 v[40:43], v[88:91], v[136:139], v[40:43]
    v_mul_f32 v161, v77, v161
    v_mul_f32 v162, v77, v162
    v_mfma_f32_16x16x32_bf16 v[40:43], v[92:95], v[132:135], v[40:43]
    v_mul_f32 v163, v77, v163
    v_mfma_f32_16x16x32_bf16 v[40:43], v[96:99], v[128:131], v[40:43]
    ds_write_b128 v56, v[32:35] offset:5120
    v_mfma_f32_16x16x32_bf16 v[40:43], v[100:103], v[124:127], v[40:43]
    v_mfma_f32_16x16x32_bf16 v[40:43], v[104:107], v[120:123], v[40:43]
    v_mfma_f32_16x16x32_bf16 v[40:43], v[108:111], v[116:119], v[40:43]
    v_mfma_f32_16x16x32_bf16 v[44:47], v[84:87], v[144:147], v[44:47]
    ds_write_b128 v56, v[36:39] offset:6400
    v_mfma_f32_16x16x32_bf16 v[44:47], v[88:91], v[140:143], v[44:47]
    v_mfma_f32_16x16x32_bf16 v[44:47], v[92:95], v[136:139], v[44:47]
    v_mfma_f32_16x16x32_bf16 v[44:47], v[96:99], v[132:135], v[44:47]
    v_mfma_f32_16x16x32_bf16 v[44:47], v[100:103], v[128:131], v[44:47]
    s_nop 1
    ds_write_b128 v56, v[40:43] offset:7680
    v_mfma_f32_16x16x32_bf16 v[44:47], v[104:107], v[124:127], v[44:47]
    v_mfma_f32_16x16x32_bf16 v[44:47], v[108:111], v[120:123], v[44:47]
    v_mfma_f32_16x16x32_bf16 v[44:47], v[112:115], v[116:119], v[44:47]
    s_add_u32 s52, s60, 98304
    buffer_load_dword v61, v80, s[12:15], s52 offen sc1
    s_nop 5
    ds_write_b128 v56, v[44:47] offset:8960
    s_waitcnt vmcnt(1) lgkmcnt(0)
    s_barrier
    ds_read_b128 v[16:19], v78 offset:0
    ds_read_b128 v[20:23], v78 offset:10240
    ds_read_b128 v[24:27], v78 offset:20480
    ds_read_b128 v[28:31], v78 offset:30720
    ds_read_b128 v[32:35], v78 offset:1280
    ds_read_b128 v[36:39], v78 offset:11520
    ds_read_b128 v[40:43], v78 offset:21760
    ds_read_b128 v[44:47], v78 offset:32000
    s_waitcnt lgkmcnt(4)
    v_pk_add_f32 v[16:17], v[16:17], v[20:21]
    v_pk_add_f32 v[18:19], v[18:19], v[22:23]
    v_pk_add_f32 v[24:25], v[24:25], v[28:29]
    v_pk_add_f32 v[26:27], v[26:27], v[30:31]
    v_pk_add_f32 v[16:17], v[16:17], v[148:149]
    v_pk_add_f32 v[18:19], v[18:19], v[150:151]
    v_pk_add_f32 v[24:25], v[24:25], v[152:153]
    v_pk_add_f32 v[26:27], v[26:27], v[154:155]
    v_cvt_pk_bf16_f32 v212, v16, v24
    v_cvt_pk_bf16_f32 v213, v17, v25
    v_cvt_pk_bf16_f32 v214, v18, v26
    v_cvt_pk_bf16_f32 v215, v19, v27
    v_and_or_b32 v212, v212, s54, v72
    v_and_or_b32 v213, v213, s54, v73
    v_and_or_b32 v214, v214, s54, v74
    v_and_or_b32 v215, v215, s54, v75
    buffer_store_dwordx4 v[212:215], v66, s[12:15], s58 offen sc1
    s_waitcnt lgkmcnt(0)
    v_pk_add_f32 v[32:33], v[32:33], v[36:37]
    v_pk_add_f32 v[34:35], v[34:35], v[38:39]
    v_pk_add_f32 v[40:41], v[40:41], v[44:45]
    v_pk_add_f32 v[42:43], v[42:43], v[46:47]
    v_pk_add_f32 v[32:33], v[32:33], v[156:157]
    v_pk_add_f32 v[34:35], v[34:35], v[158:159]
    v_pk_add_f32 v[40:41], v[40:41], v[160:161]
    v_pk_add_f32 v[42:43], v[42:43], v[162:163]
    v_cvt_pk_bf16_f32 v216, v32, v40
    v_cvt_pk_bf16_f32 v217, v33, v41
    v_cvt_pk_bf16_f32 v218, v34, v42
    v_cvt_pk_bf16_f32 v219, v35, v43
    v_and_or_b32 v216, v216, s54, v72
    v_and_or_b32 v217, v217, s54, v73
    v_and_or_b32 v218, v218, s54, v74
    v_and_or_b32 v219, v219, s54, v75
    s_add_u32 s58, s58, 32768
    buffer_store_dwordx4 v[216:219], v66, s[12:15], s58 offen sc1
    s_waitcnt vmcnt(2)
    v_cmp_ne_u32 vcc, s43, v61
    s_nop 4
    s_cbranch_vccnz L_slow_13
L_back_14:
    s_add_u32 s82, s80, 24576
    buffer_load_dwordx4 a[0:3], v58, s[12:15], s82 offen sc1
    s_add_u32 s82, s80, 26624
    buffer_load_dwordx4 a[4:7], v58, s[12:15], s82 offen sc1
    s_add_u32 s82, s80, 20480
    buffer_load_dwordx4 a[8:11], v58, s[12:15], s82 offen sc1
    ds_read_b128 a[112:115], v71 offset:32768
    ds_read_b128 a[116:119], v71 offset:33792
    ds_read_b128 a[120:123], v71 offset:34816
    ds_read_b128 a[124:127], v71 offset:35840
    s_add_u32 s82, s80, 22528
    buffer_load_dwordx4 a[12:15], v58, s[12:15], s82 offen sc1
    ds_read_b128 a[128:131], v71 offset:40960
    ds_read_b128 a[132:135], v71 offset:41984
    ds_read_b128 a[136:139], v71 offset:43008
    ds_read_b128 a[140:143], v71 offset:44032
    s_add_u32 s82, s80, 16384
    buffer_load_dwordx4 a[16:19], v58, s[12:15], s82 offen sc1
    ds_read_b128 a[144:147], v71 offset:16384
    ds_read_b128 a[148:151], v71 offset:17408
    ds_read_b128 a[152:155], v71 offset:18432
    ds_read_b128 a[156:159], v71 offset:19456
    s_add_u32 s82, s80, 18432
    buffer_load_dwordx4 a[20:23], v58, s[12:15], s82 offen sc1
    ds_read_b128 a[160:163], v71 offset:24576
    ds_read_b128 a[164:167], v71 offset:25600
    ds_read_b128 a[168:171], v71 offset:26624
    ds_read_b128 a[172:175], v71 offset:27648
    s_add_u32 s82, s79, 12288
    buffer_load_dwordx4 a[24:27], v58, s[12:15], s82 offen sc1
    ds_read_b128 a[176:179], v71 offset:0
    ds_read_b128 a[180:183], v71 offset:1024
    ds_read_b128 a[184:187], v71 offset:2048
    ds_read_b128 a[188:191], v71 offset:3072
    s_add_u32 s82, s80, 14336
    buffer_load_dwordx4 a[28:31], v58, s[12:15], s82 offen sc1
    ds_read_b128 a[192:195], v71 offset:8192
    ds_read_b128 a[196:199], v71 offset:9216
    ds_read_b128 a[200:203], v71 offset:10240
    ds_read_b128 a[204:207], v71 offset:11264
    s_add_u32 s82, s79, 8192
    buffer_load_dwordx4 a[32:35], v58, s[12:15], s82 offen sc1
    ds_read_b128 a[208:211], v58 offset:49152
    ds_read_b128 a[212:215], v58 offset:50176
    ds_read_b128 a[216:219], v58 offset:51200
    ds_read_b128 a[220:223], v58 offset:52224
    s_add_u32 s82, s79, 10240
    buffer_load_dwordx4 a[36:39], v58, s[12:15], s82 offen sc1
    ds_read_b128 a[224:227], v58 offset:57344
    ds_read_b128 a[228:231], v58 offset:58368
    ds_read_b128 a[232:235], v58 offset:59392
    ds_read_b128 a[236:239], v58 offset:60416
    s_add_u32 s82, s79, 4096
    buffer_load_dwordx4 a[40:43], v58, s[12:15], s82 offen sc1
    ds_read_b128 a[240:243], v58 offset:32768
    ds_read_b128 a[244:247], v58 offset:33792
    ds_read_b128 a[248:251], v58 offset:34816
    ds_read_b128 a[252:255], v58 offset:35840
    ds_read_b128 v[84:87], v58 offset:40960
    ds_read_b128 v[88:91], v58 offset:41984
    ds_read_b128 v[92:95], v58 offset:43008
    ds_read_b128 v[96:99], v58 offset:44032
    ds_read_b128 v[100:103], v58 offset:16384
    ds_read_b128 v[104:107], v58 offset:17408
    ds_read_b128 v[108:111], v58 offset:18432
    ds_read_b128 v[112:115], v58 offset:19456
    ds_read_b128 v[116:119], v58 offset:24576
    ds_read_b128 v[120:123], v58 offset:25600
    ds_read_b128 v[124:127], v58 offset:26624
    ds_read_b128 v[128:131], v58 offset:27648
    s_waitcnt vmcnt(10)
    s_waitcnt lgkmcnt(15)
    v_mfma_f32_16x16x32_bf16 v[16:19], a[112:115], a[0:3], 0
    s_add_u32 s82, s79, 6144
    buffer_load_dwordx4 a[44:47], v58, s[12:15], s82 offen sc1
    v_mfma_f32_16x16x32_bf16 v[20:23], a[116:119], a[0:3], 0
    ds_read_b128 v[132:135], v58 offset:0
    s_or_b32 s45, s42, s36
    v_mfma_f32_16x16x32_bf16 v[24:27], a[120:123], a[0:3], 0
    s_min_u32 s45, s45, 1
    ds_read_b128 v[136:139], v58 offset:1024
    s_lshl_b32 s45, s45, 30
    v_mfma_f32_16x16x32_bf16 v[28:31], a[124:127], a[0:3], 0
    s_waitcnt vmcnt(10)
    ds_read_b128 v[140:143], v58 offset:2048
    v_mov_b32 v3, s45
    v_mfma_f32_16x16x32_bf16 v[16:19], a[128:131], a[4:7], v[16:19]
    s_add_u32 s82, s79, 0
    buffer_load_dwordx4 a[48:51], v58, s[12:15], s82 offen sc1
    v_mfma_f32_16x16x32_bf16 v[20:23], a[132:135], a[4:7], v[20:23]
    ds_read_b128 v[144:147], v58 offset:3072
    s_mul_i32 s45, s36, 10240
    v_mfma_f32_16x16x32_bf16 v[24:27], a[136:139], a[4:7], v[24:27]
    s_add_u32 s45, s45, 114688
    ds_read_b128 v[148:151], v58 offset:8192
    s_mul_i32 s46, s36, 2560
    v_mfma_f32_16x16x32_bf16 v[28:31], a[140:143], a[4:7], v[28:31]
    s_waitcnt vmcnt(10)
    ds_read_b128 v[152:155], v58 offset:9216
    s_add_u32 s45, s45, s46
    v_mfma_f32_16x16x32_bf16 v[16:19], a[144:147], a[8:11], v[16:19]
    s_add_u32 s82, s79, 2048
    buffer_load_dwordx4 a[52:55], v58, s[12:15], s82 offen sc1
    v_mfma_f32_16x16x32_bf16 v[20:23], a[148:151], a[8:11], v[20:23]
    ds_read_b128 v[156:159], v58 offset:10240
    v_and_b32 v2, 15, v0
    v_mfma_f32_16x16x32_bf16 v[24:27], a[152:155], a[8:11], v[24:27]
    ds_read_b128 v[160:163], v58 offset:11264
    v_mul_u32_u24 v2, 144, v2
    v_mfma_f32_16x16x32_bf16 v[28:31], a[156:159], a[8:11], v[28:31]
    s_waitcnt vmcnt(10)
L_pad6:
    s_cbranch_execz L_warm
    ds_read_b128 v[164:167], v71 offset:36864
    v_bfe_u32 v50, v0, 4, 1
    v_mfma_f32_16x16x32_bf16 v[16:19], a[160:163], a[12:15], v[16:19]
    s_add_u32 s82, s80, 25600
    buffer_load_dwordx4 a[56:59], v58, s[12:15], s82 offen sc1
    v_mfma_f32_16x16x32_bf16 v[20:23], a[164:167], a[12:15], v[20:23]
    ds_read_b128 v[168:171], v71 offset:37888
    v_lshl_add_u32 v2, v50, 5, v2
    v_mfma_f32_16x16x32_bf16 v[24:27], a[168:171], a[12:15], v[24:27]
    ds_read_b128 v[172:175], v71 offset:38912
    v_lshrrev_b32 v50, 5, v0
    v_mfma_f32_16x16x32_bf16 v[28:31], a[172:175], a[12:15], v[28:31]
    s_waitcnt vmcnt(10)
    ds_read_b128 v[176:179], v71 offset:39936
    v_lshl_add_u32 v2, v50, 4, v2
    v_mfma_f32_16x16x32_bf16 v[16:19], a[176:179], a[16:19], v[16:19]
    s_add_u32 s82, s80, 27648
    buffer_load_dwordx4 a[60:63], v58, s[12:15], s82 offen sc1
    v_mfma_f32_16x16x32_bf16 v[20:23], a[180:183], a[16:19], v[20:23]
    ds_read_b128 v[180:183], v71 offset:45056
    v_add_u32 v50, s45, v2
    v_mfma_f32_16x16x32_bf16 v[24:27], a[184:187], a[16:19], v[24:27]
    ds_read_b128 v[184:187], v71 offset:46080
    v_mul_u32_u24 v2, 144, v63
    v_mfma_f32_16x16x32_bf16 v[28:31], a[188:191], a[16:19], v[28:31]
    s_waitcnt vmcnt(10)
    ds_read_b128 v[188:191], v71 offset:47104
    v_and_b32 v69, 0x70, v58
    v_mfma_f32_16x16x32_bf16 v[16:19], a[192:195], a[20:23], v[16:19]
    s_add_u32 s82, s80, 21504
    buffer_load_dwordx4 a[64:67], v58, s[12:15], s82 offen sc1
    v_mfma_f32_16x16x32_bf16 v[20:23], a[196:199], a[20:23], v[20:23]
    ds_read_b128 v[192:195], v71 offset:48128
    s_mov_b32 s52, 32768
    v_mfma_f32_16x16x32_bf16 v[24:27], a[200:203], a[20:23], v[24:27]
    buffer_load_dwordx2 v[48:49], v70, s[12:15], s52 offen sc1
    v_mfma_f32_16x16x32_bf16 v[28:31], a[204:207], a[20:23], v[28:31]
    s_waitcnt vmcnt(11)
    ds_read_b128 v[196:199], v71 offset:20480
    v_add3_u32 v51, v2, v69, s45
    v_mfma_f32_16x16x32_bf16 v[16:19], a[208:211], a[24:27], v[16:19]
    s_add_u32 s82, s80, 23552
    buffer_load_dwordx4 a[68:71], v58, s[12:15], s82 offen sc1
    v_mfma_f32_16x16x32_bf16 v[20:23], a[212:215], a[24:27], v[20:23]
    ds_read_b128 v[200:203], v71 offset:21504
    v_and_b32 v2, 4, v63
    v_mfma_f32_16x16x32_bf16 v[24:27], a[216:219], a[24:27], v[24:27]
    s_lshl_b32 s45, s61, 5
    buffer_load_dword v32, v68, s[12:15], s59 offen offset:0 sc1
    v_mfma_f32_16x16x32_bf16 v[28:31], a[220:223], a[24:27], v[28:31]
    s_waitcnt vmcnt(12)
    ds_read_b128 v[204:207], v71 offset:22528
    s_lshl2_add_u32 s45, s38, s45
    v_mfma_f32_16x16x32_bf16 v[16:19], a[224:227], a[28:31], v[16:19]
    s_add_u32 s82, s80, 17408
    buffer_load_dwordx4 a[72:75], v58, s[12:15], s82 offen sc1
    v_mfma_f32_16x16x32_bf16 v[20:23], a[228:231], a[28:31], v[20:23]
    ds_read_b128 v[208:211], v71 offset:23552
    v_add3_u32 v2, v2, v63, s45
    v_mfma_f32_16x16x32_bf16 v[24:27], a[232:235], a[28:31], v[24:27]
    buffer_load_dword v34, v68, s[12:15], s59 offen offset:128 sc1
    v_mfma_f32_16x16x32_bf16 v[28:31], a[236:239], a[28:31], v[28:31]
    s_waitcnt vmcnt(13) lgkmcnt(15)
    ds_read_b128 a[112:115], v71 offset:28672
    v_mul_u32_u24 v2, 896, v2
    v_mfma_f32_16x16x32_bf16 v[16:19], a[240:243], a[32:35], v[16:19]
    s_add_u32 s82, s80, 19456
    buffer_load_dwordx4 a[76:79], v58, s[12:15], s82 offen sc1
    v_mfma_f32_16x16x32_bf16 v[20:23], a[244:247], a[32:35], v[20:23]
    ds_read_b128 a[116:119], v71 offset:29696
    s_lshl_b32 s45, s37, 7
    v_mfma_f32_16x16x32_bf16 v[24:27], a[248:251], a[32:35], v[24:27]
    buffer_load_dword v36, v68, s[12:15], s59 offen offset:1024 sc1
    v_mfma_f32_16x16x32_bf16 v[28:31], a[252:255], a[32:35], v[28:31]
    s_waitcnt vmcnt(14)
    ds_read_b128 a[120:123], v71 offset:30720
    v_add3_u32 v69, v2, v69, s45
    v_mfma_f32_16x16x32_bf16 v[16:19], v[84:87], a[36:39], v[16:19]
    s_add_u32 s82, s79, 13312
    buffer_load_dwordx4 a[80:83], v58, s[12:15], s82 offen sc1
    v_mfma_f32_16x16x32_bf16 v[20:23], v[88:91], a[36:39], v[20:23]
    ds_read_b128 a[124:127], v71 offset:31744
    s_mov_b32 s61, 14336
    v_mfma_f32_16x16x32_bf16 v[24:27], v[92:95], a[36:39], v[24:27]
    buffer_load_dword v38, v68, s[12:15], s59 offen offset:1152 sc1
    v_mfma_f32_16x16x32_bf16 v[28:31], v[96:99], a[36:39], v[28:31]
    s_waitcnt vmcnt(15)
    ds_read_b128 a[128:131], v71 offset:4096
    v_lshlrev_b32 v220, 16, v8
    v_mfma_f32_16x16x32_bf16 v[16:19], v[100:103], a[40:43], v[16:19]
    s_add_u32 s82, s80, 15360
    buffer_load_dwordx4 a[84:87], v58, s[12:15], s82 offen sc1
    v_mfma_f32_16x16x32_bf16 v[20:23], v[104:107], a[40:43], v[20:23]
    ds_read_b128 a[132:135], v71 offset:5120
    v_and_b32 v221, 0xffff0000, v8
    v_mfma_f32_16x16x32_bf16 v[24:27], v[108:111], a[40:43], v[24:27]
    buffer_load_dword v40, v68, s[12:15], s59 offen offset:2048 sc1
    v_mfma_f32_16x16x32_bf16 v[28:31], v[112:115], a[40:43], v[28:31]
    s_waitcnt vmcnt(16)
    ds_read_b128 a[136:139], v71 offset:6144
    v_lshlrev_b32 v222, 16, v9
    v_mfma_f32_16x16x32_bf16 v[16:19], v[116:119], a[44:47], v[16:19]
    s_add_u32 s82, s79, 9216
    buffer_load_dwordx4 a[88:91], v58, s[12:15], s82 offen sc1
    v_mfma_f32_16x16x32_bf16 v[20:23], v[120:123], a[44:47], v[20:23]
    ds_read_b128 a[140:143], v71 offset:7168
    v_and_b32 v223, 0xffff0000, v9
    v_mfma_f32_16x16x32_bf16 v[24:27], v[124:127], a[44:47], v[24:27]
    buffer_load_dword v42, v68, s[12:15], s59 offen offset:2176 sc1
    v_mfma_f32_16x16x32_bf16 v[28:31], v[128:131], a[44:47], v[28:31]
    s_waitcnt vmcnt(17)
    ds_read_b128 a[144:147], v71 offset:12288
    v_lshlrev_b32 v224, 16, v10
    v_mfma_f32_16x16x32_bf16 v[16:19], v[132:135], a[48:51], v[16:19]
    s_add_u32 s82, s79, 11264
    buffer_load_dwordx4 a[92:95], v58, s[12:15], s82 offen sc1
    v_mfma_f32_16x16x32_bf16 v[20:23], v[136:139], a[48:51], v[20:23]
    ds_read_b128 a[148:151], v71 offset:13312
    v_and_b32 v225, 0xffff0000, v10
    v_mfma_f32_16x16x32_bf16 v[24:27], v[140:143], a[48:51], v[24:27]
    buffer_load_dword v44, v68, s[12:15], s59 offen offset:3072 sc1
    v_mfma_f32_16x16x32_bf16 v[28:31], v[144:147], a[48:51], v[28:31]
    s_waitcnt vmcnt(18) lgkmcnt(15)
    ds_read_b128 a[152:155], v71 offset:14336
    v_lshlrev_b32 v226, 16, v11
    v_mfma_f32_16x16x32_bf16 v[16:19], v[148:151], a[52:55], v[16:19]
    s_add_u32 s82, s79, 5120
    buffer_load_dwordx4 a[96:99], v58, s[12:15], s82 offen sc1
    v_mfma_f32_16x16x32_bf16 v[20:23], v[152:155], a[52:55], v[20:23]
    ds_read_b128 a[156:159], v71 offset:15360
    v_and_b32 v227, 0xffff0000, v11
    v_mfma_f32_16x16x32_bf16 v[24:27], v[156:159], a[52:55], v[24:27]
    buffer_load_dword v46, v68, s[12:15], s59 offen offset:3200 sc1
    v_mfma_f32_16x16x32_bf16 v[28:31], v[160:163], a[52:55], v[28:31]
    s_waitcnt vmcnt(19)
    ds_read_b128 a[160:163], v58 offset:53248
    v_lshlrev_b32 v228, 16, v12
    v_mfma_f32_16x16x32_bf16 v[16:19], v[164:167], a[56:59], v[16:19]
    s_add_u32 s82, s79, 7168
    buffer_load_dwordx4 a[100:103], v58, s[12:15], s82 offen sc1
    v_mfma_f32_16x16x32_bf16 v[20:23], v[168:171], a[56:59], v[20:23]
    ds_read_b128 a[164:167], v58 offset:54272
    v_and_b32 v229, 0xffff0000, v12
    v_mfma_f32_16x16x32_bf16 v[24:27], v[172:175], a[56:59], v[24:27]
    ds_read_b128 a[168:171], v58 offset:55296
    v_lshlrev_b32 v230, 16, v13
    v_mfma_f32_16x16x32_bf16 v[28:31], v[176:179], a[56:59], v[28:31]
    s_waitcnt vmcnt(19)
    ds_read_b128 a[172:175], v58 offset:56320
    v_and_b32 v231, 0xffff0000, v13
    v_mfma_f32_16x16x32_bf16 v[16:19], v[180:183], a[60:63], v[16:19]
    s_add_u32 s82, s79, 1024
    buffer_load_dwordx4 a[104:107], v58, s[12:15], s82 offen sc1
    v_mfma_f32_16x16x32_bf16 v[20:23], v[184:187], a[60:63], v[20:23]
    s_waitcnt lgkmcnt(15)
    ds_read_b128 a[176:179], v58 offset:61440
    v_lshlrev_b32 v232, 16, v14
    v_mfma_f32_16x16x32_bf16 v[24:27], v[188:191], a[60:63], v[24:27]
    ds_read_b128 a[180:183], v58 offset:62464
    v_and_b32 v233, 0xffff0000, v14
    v_mfma_f32_16x16x32_bf16 v[28:31], v[192:195], a[60:63], v[28:31]
    s_waitcnt vmcnt(19)
    ds_read_b128 a[184:187], v58 offset:63488
    v_lshlrev_b32 v234, 16, v15
    v_mfma_f32_16x16x32_bf16 v[16:19], v[196:199], a[64:67], v[16:19]
    s_add_u32 s82, s79, 3072
    buffer_load_dwordx4 a[108:111], v58, s[12:15], s82 offen sc1
    v_mfma_f32_16x16x32_bf16 v[20:23], v[200:203], a[64:67], v[20:23]
    ds_read_b128 a[188:191], v58 offset:64512
    v_and_b32 v235, 0xffff0000, v15
    v_mfma_f32_16x16x32_bf16 v[24:27], v[204:207], a[64:67], v[24:27]
    ds_read_b128 a[192:195], v58 offset:36864
    v_mfma_f32_16x16x32_bf16 v[28:31], v[208:211], a[64:67], v[28:31]
    s_waitcnt vmcnt(18) lgkmcnt(15)
    ds_read_b128 a[196:199], v58 offset:37888
    v_mfma_f32_16x16x32_bf16 v[16:19], a[112:115], a[68:71], v[16:19]
    ds_read_b128 a[200:203], v58 offset:38912
    v_mfma_f32_16x16x32_bf16 v[20:23], a[116:119], a[68:71], v[20:23]
    ds_read_b128 a[204:207], v58 offset:39936
    v_mfma_f32_16x16x32_bf16 v[24:27], a[120:123], a[68:71], v[24:27]
    ds_read_b128 a[208:211], v58 offset:45056
    v_mfma_f32_16x16x32_bf16 v[28:31], a[124:127], a[68:71], v[28:31]
    s_waitcnt vmcnt(16)
    ds_read_b128 a[212:215], v58 offset:46080
    v_mfma_f32_16x16x32_bf16 v[16:19], a[128:131], a[72:75], v[16:19]
    ds_read_b128 a[216:219], v58 offset:47104
    v_mfma_f32_16x16x32_bf16 v[20:23], a[132:135], a[72:75], v[20:23]
    s_waitcnt lgkmcnt(15)
    ds_read_b128 a[220:223], v58 offset:48128
    v_mfma_f32_16x16x32_bf16 v[24:27], a[136:139], a[72:75], v[24:27]
    ds_read_b128 a[224:227], v58 offset:20480
    v_mfma_f32_16x16x32_bf16 v[28:31], a[140:143], a[72:75], v[28:31]
    s_waitcnt vmcnt(14)
    ds_read_b128 a[228:231], v58 offset:21504
    v_mfma_f32_16x16x32_bf16 v[16:19], a[144:147], a[76:79], v[16:19]
    ds_read_b128 a[232:235], v58 offset:22528
    v_mfma_f32_16x16x32_bf16 v[20:23], a[148:151], a[76:79], v[20:23]
    ds_read_b128 a[236:239], v58 offset:23552
    v_mfma_f32_16x16x32_bf16 v[24:27], a[152:155], a[76:79], v[24:27]
    ds_read_b128 a[240:243], v58 offset:28672
    v_mfma_f32_16x16x32_bf16 v[28:31], a[156:159], a[76:79], v[28:31]
    s_waitcnt vmcnt(12) lgkmcnt(15)
    ds_read_b128 a[244:247], v58 offset:29696
    v_mfma_f32_16x16x32_bf16 v[16:19], a[160:163], a[80:83], v[16:19]
    ds_read_b128 a[248:251], v58 offset:30720
    v_mfma_f32_16x16x32_bf16 v[20:23], a[164:167], a[80:83], v[20:23]
    ds_read_b128 a[252:255], v58 offset:31744
    v_mfma_f32_16x16x32_bf16 v[24:27], a[168:171], a[80:83], v[24:27]
    ds_read_b128 v[84:87], v58 offset:4096
    v_mfma_f32_16x16x32_bf16 v[28:31], a[172:175], a[80:83], v[28:31]
    s_waitcnt vmcnt(10)
    ds_read_b128 v[88:91], v58 offset:5120
    v_mfma_f32_16x16x32_bf16 v[16:19], a[176:179], a[84:87], v[16:19]
    ds_read_b128 v[92:95], v58 offset:6144
    v_mfma_f32_16x16x32_bf16 v[20:23], a[180:183], a[84:87], v[20:23]
    s_waitcnt lgkmcnt(15)
    ds_read_b128 v[96:99], v58 offset:7168
    v_mfma_f32_16x16x32_bf16 v[24:27], a[184:187], a[84:87], v[24:27]
    ds_read_b128 v[100:103], v58 offset:12288
    v_mfma_f32_16x16x32_bf16 v[28:31], a[188:191], a[84:87], v[28:31]
    s_waitcnt vmcnt(8)
    ds_read_b128 v[104:107], v58 offset:13312
    v_mfma_f32_16x16x32_bf16 v[16:19], a[192:195], a[88:91], v[16:19]
    ds_read_b128 v[108:111], v58 offset:14336
    v_mfma_f32_16x16x32_bf16 v[20:23], a[196:199], a[88:91], v[20:23]
    ds_read_b128 v[112:115], v58 offset:15360
    v_mfma_f32_16x16x32_bf16 v[24:27], a[200:203], a[88:91], v[24:27]
    s_waitcnt vmcnt(3)
    v_xor_b32 v1, v32, v62
    v_bitop3_b32 v1, v1, v34, v62 bitop3:0xf6
    v_mfma_f32_16x16x32_bf16 v[28:31], a[204:207], a[88:91], v[28:31]
    s_waitcnt lgkmcnt(15)
    v_bitop3_b32 v1, v1, v36, v62 bitop3:0xf6
    v_bitop3_b32 v1, v1, v38, v62 bitop3:0xf6
    v_mfma_f32_16x16x32_bf16 v[16:19], a[208:211], a[92:95], v[16:19]
    v_bitop3_b32 v1, v1, v40, v62 bitop3:0xf6
    v_bitop3_b32 v1, v1, v42, v62 bitop3:0xf6
    v_mfma_f32_16x16x32_bf16 v[20:23], a[212:215], a[92:95], v[20:23]
    v_bitop3_b32 v1, v1, v44, v62 bitop3:0xf6
    v_bitop3_b32 v1, v1, v46, v62 bitop3:0xf6
    v_mfma_f32_16x16x32_bf16 v[24:27], a[216:219], a[92:95], v[24:27]
    v_and_b32 v1, 0x00010001, v1
    v_bitop3_b32 v1, v1, v49, v4 bitop3:0xf6
    v_mfma_f32_16x16x32_bf16 v[28:31], a[220:223], a[92:95], v[28:31]
    s_waitcnt lgkmcnt(14)
    v_cmp_ne_u32 vcc, 0, v1
    v_mfma_f32_16x16x32_bf16 v[16:19], a[224:227], a[96:99], v[16:19]
    v_mfma_f32_16x16x32_bf16 v[20:23], a[228:231], a[96:99], v[20:23]
    s_waitcnt lgkmcnt(12)
    s_nop 1
    s_cbranch_vccnz L_slow_15
L_back_16:
    v_and_b32 v32, s54, v32
    v_mfma_f32_16x16x32_bf16 v[24:27], a[232:235], a[96:99], v[24:27]
    v_and_or_b32 v33, v32, s55, v79
    v_lshl_or_b32 v32, v32, 16, v79
    v_mfma_f32_16x16x32_bf16 v[28:31], a[236:239], a[96:99], v[28:31]
    s_waitcnt vmcnt(2) lgkmcnt(10)
    v_and_b32 v34, s54, v34
    v_and_or_b32 v35, v34, s55, v79
    v_mfma_f32_16x16x32_bf16 v[16:19], a[240:243], a[100:103], v[16:19]
    v_lshl_or_b32 v34, v34, 16, v79
    v_and_b32 v36, s54, v36
    v_mfma_f32_16x16x32_bf16 v[20:23], a[244:247], a[100:103], v[20:23]
    s_waitcnt lgkmcnt(8)
    v_and_or_b32 v37, v36, s55, v79
    v_lshl_or_b32 v36, v36, 16, v79
    v_mfma_f32_16x16x32_bf16 v[24:27], a[248:251], a[100:103], v[24:27]
    v_and_b32 v38, s54, v38
    v_and_or_b32 v39, v38, s55, v79
    v_mfma_f32_16x16x32_bf16 v[28:31], a[252:255], a[100:103], v[28:31]
    s_waitcnt vmcnt(1) lgkmcnt(6)
    v_lshl_or_b32 v38, v38, 16, v79
    v_and_b32 v40, s54, v40
    v_mfma_f32_16x16x32_bf16 v[16:19], v[84:87], a[104:107], v[16:19]
    v_and_or_b32 v41, v40, s55, v79
    v_lshl_or_b32 v40, v40, 16, v79
    v_mfma_f32_16x16x32_bf16 v[20:23], v[88:91], a[104:107], v[20:23]
    s_waitcnt lgkmcnt(4)
    v_and_b32 v42, s54, v42
    v_and_or_b32 v43, v42, s55, v79
    v_mfma_f32_16x16x32_bf16 v[24:27], v[92:95], a[104:107], v[24:27]
    v_lshl_or_b32 v42, v42, 16, v79
    v_and_b32 v44, s54, v44
    v_mfma_f32_16x16x32_bf16 v[28:31], v[96:99], a[104:107], v[28:31]
    s_waitcnt vmcnt(0) lgkmcnt(2)
    v_and_or_b32 v45, v44, s55, v79
    v_lshl_or_b32 v44, v44, 16, v79
    v_mfma_f32_16x16x32_bf16 v[16:19], v[100:103], a[108:111], v[16:19]
    v_and_b32 v46, s54, v46
    v_and_or_b32 v47, v46, s55, v79
    v_mfma_f32_16x16x32_bf16 v[20:23], v[104:107], a[108:111], v[20:23]
    s_waitcnt lgkmcnt(0)
    v_lshl_or_b32 v46, v46, 16, v79
    v_mfma_f32_16x16x32_bf16 v[24:27], v[108:111], a[108:111], v[24:27]
    v_mfma_f32_16x16x32_bf16 v[28:31], v[112:115], a[108:111], v[28:31]
    s_nop 0
    v_pk_fma_f32 v[32:33], v[32:33], v[220:221], v[16:17] neg_lo:[0,0,1] neg_hi:[0,0,1]
    v_pk_fma_f32 v[34:35], v[34:35], v[222:223], v[18:19] neg_lo:[0,0,1] neg_hi:[0,0,1]
    s_nop 0
    v_pk_fma_f32 v[36:37], v[36:37], v[224:225], v[20:21] neg_lo:[0,0,1] neg_hi:[0,0,1]
    v_pk_fma_f32 v[38:39], v[38:39], v[226:227], v[22:23] neg_lo:[0,0,1] neg_hi:[0,0,1]
    v_pk_fma_f32 v[32:33], v[32:33], v[48:49], v[16:17] op_sel_hi:[1,0,1]
    v_pk_fma_f32 v[34:35], v[34:35], v[48:49], v[18:19] op_sel_hi:[1,0,1]
    v_pk_fma_f32 v[36:37], v[36:37], v[48:49], v[20:21] op_sel_hi:[1,0,1]
    v_pk_fma_f32 v[38:39], v[38:39], v[48:49], v[22:23] op_sel_hi:[1,0,1]
    v_cvt_pk_bf16_f32 v236, v32, v33
    v_cvt_pk_bf16_f32 v237, v34, v35
    v_cvt_pk_bf16_f32 v238, v36, v37
    v_cvt_pk_bf16_f32 v239, v38, v39
    s_nop 0
    v_permlane16_swap_b32 v236, v238
    v_permlane16_swap_b32 v237, v239
    ds_write_b128 v50, v[236:239] offset:0
    v_pk_fma_f32 v[40:41], v[40:41], v[228:229], v[24:25] neg_lo:[0,0,1] neg_hi:[0,0,1]
    v_pk_fma_f32 v[42:43], v[42:43], v[230:231], v[26:27] neg_lo:[0,0,1] neg_hi:[0,0,1]
    v_pk_fma_f32 v[44:45], v[44:45], v[232:233], v[28:29] neg_lo:[0,0,1] neg_hi:[0,0,1]
    v_pk_fma_f32 v[46:47], v[46:47], v[234:235], v[30:31] neg_lo:[0,0,1] neg_hi:[0,0,1]
    v_pk_fma_f32 v[40:41], v[40:41], v[48:49], v[24:25] op_sel_hi:[1,0,1]
    v_pk_fma_f32 v[42:43], v[42:43], v[48:49], v[26:27] op_sel_hi:[1,0,1]
    v_pk_fma_f32 v[44:45], v[44:45], v[48:49], v[28:29] op_sel_hi:[1,0,1]
    v_pk_fma_f32 v[46:47], v[46:47], v[48:49], v[30:31] op_sel_hi:[1,0,1]
    v_cvt_pk_bf16_f32 v240, v40, v41
    v_cvt_pk_bf16_f32 v241, v42, v43
    v_cvt_pk_bf16_f32 v242, v44, v45
    v_cvt_pk_bf16_f32 v243, v46, v47
    s_nop 0
    v_permlane16_swap_b32 v240, v242
    v_permlane16_swap_b32 v241, v243
    ds_write_b128 v50, v[240:243] offset:64
    ds_read_b128 v[236:239], v51 offset:0
    ds_read_b128 v[240:243], v51 offset:1152
    s_waitcnt lgkmcnt(0)
    buffer_store_dwordx4 v[236:239], v69, s[28:31], 0 offen sc1
    buffer_store_dwordx4 v[240:243], v69, s[28:31], s61 offen sc1
    buffer_store_dword v4, v3, s[12:15], 0 offen sc1
    s_endpgm
L_notworker:
    s_load_dwordx2 s[64:65], s[0:1], 8
    s_load_dwordx2 s[68:69], s[0:1], 16
    s_load_dwordx2 s[72:73], s[0:1], 24
    s_load_dwordx2 s[20:21], s[0:1], 32
    s_load_dwordx2 s[24:25], s[0:1], 80
    s_load_dwordx2 s[76:77], s[0:1], 88
    s_load_dword s43, s[12:13], 0
    s_mov_b32 s6, 1835008
    s_mov_b32 s7, 0x20000
    s_mov_b32 s22, 1835008
    s_mov_b32 s23, 0x20000
    s_mov_b32 s26, 802816
    s_mov_b32 s27, 0x20000
    s_mov_b32 s14, 25165824
    s_mov_b32 s15, 0x20000
    s_mov_b32 s66, 1835008
    s_mov_b32 s67, 0x20000
    s_mov_b32 s70, 1835008
    s_mov_b32 s71, 0x20000
    s_mov_b32 s74, 3584
    s_mov_b32 s75, 0x20000
    s_mov_b32 s78, 896
    s_mov_b32 s79, 0x20000
    v_and_b32 v1, 7, v0
    v_lshlrev_b32 v13, 4, v0
    v_lshlrev_b32 v2, 4, v1
    v_mul_u32_u24 v16, 896, v63
    v_add_u32 v10, v16, v2
    s_mul_i32 s46, s84, 57344
    s_cmp_eq_u32 s84, 0
    s_cselect_b32 s45, 0x40000000, s46
    s_sub_u32 s45, s45, 7168
    v_add_u32 v12, s45, v10
    s_mul_i32 s45, s89, 14336
    v_add_u32 v10, s45, v10
    v_add_u32 v11, 6128, v10
    s_mul_i32 s87, s36, 2080
    s_lshl_b32 s45, s36, 10
    s_add_u32 m0, s45, 152576
    s_lshl_b32 s46, s36, 4
    s_lshl_b64 s[82:83], 0xffff, s46
    s_waitcnt lgkmcnt(0)
    buffer_load_dwordx4 v13, s[72:75], s45 offen lds
    v_sub_u32 v3, 7, v1
    v_mul_u32_u24 v3, 1040, v3
    s_lshl_b32 s45, s36, 5
    v_lshl_add_u32 v19, v63, 2, s45
    v_add_u32 v19, v19, v3
    v_add_u32 v20, 1040, v19
    v_add_u32 v21, 9360, v19
    s_lshl_b32 s45, s36, 7
    s_add_u32 s45, s45, 152576
    v_lshl_add_u32 v15, v63, 4, s45
    v_lshl_add_u32 v14, v63, 13, v2
    s_lshl_b32 s45, s36, 16
    s_lshl_b32 s46, s84, 7
    s_sub_u32 s45, s45, s46
    s_add_u32 s88, s45, 1052544
    v_lshrrev_b32 v2, 4, v0
    v_lshlrev_b32 v2, 1, v2
    v_xor_b32 v1, v1, v2
    v_lshl_add_u32 v16, v1, 4, v16
    v_lshrrev_b32 v1, 2, v0
    v_bfe_u32 v2, v0, 3, 2
    v_xor_b32 v2, s36, v2
    v_lshlrev_b32 v2, 5, v2
    v_lshl_add_u32 v2, v1, 7, v2
    v_and_b32 v3, 3, v0
    v_lshl_add_u32 v2, v3, 3, v2
    v_add_u32 v17, 123904, v2
    s_add_u32 s43, s43, 0x9E3779B9
    s_add_u32 m0, s87, 1040
    s_mov_b32 s46, 0
    buffer_load_dwordx4 v10, s[64:67], s46 offen lds
    buffer_load_dwordx4 v11, s[64:67], s46 offen offset:1040 lds
    s_add_u32 m0, s87, 9360
    s_nop 0
    buffer_load_dwordx4 v10, s[68:71], s46 offen lds
    buffer_load_dwordx4 v11, s[68:71], s46 offen offset:1040 lds
    s_mov_b32 m0, 0
    s_mov_b64 exec, s[82:83]
    buffer_load_dwordx4 v12, s[64:67], s46 offen lds
    s_mov_b64 exec, -1
    s_add_u32 m0, s87, 18720
    s_mov_b32 s46, 128
    buffer_load_dwordx4 v10, s[64:67], s46 offen lds
    buffer_load_dwordx4 v11, s[64:67], s46 offen offset:1040 lds
    s_add_u32 m0, s87, 27040
    s_nop 0
    buffer_load_dwordx4 v10, s[68:71], s46 offen lds
    buffer_load_dwordx4 v11, s[68:71], s46 offen offset:1040 lds
    s_mov_b32 m0, 17680
    s_mov_b64 exec, s[82:83]
    buffer_load_dwordx4 v12, s[64:67], s46 offen lds
    s_mov_b64 exec, -1
    s_waitcnt vmcnt(5)
    s_barrier
    buffer_load_dword v9, v18, s[16:19], s90 offen offset:1152
    s_add_u32 m0, s87, 36400
    s_mov_b32 s46, 256
    buffer_load_dwordx4 v10, s[64:67], s46 offen lds
    buffer_load_dwordx4 v11, s[64:67], s46 offen offset:1040 lds
    s_add_u32 m0, s87, 44720
    s_nop 0
    buffer_load_dwordx4 v10, s[68:71], s46 offen lds
    buffer_load_dwordx4 v11, s[68:71], s46 offen offset:1040 lds
    s_mov_b32 m0, 35360
    s_mov_b64 exec, s[82:83]
    buffer_load_dwordx4 v12, s[64:67], s46 offen lds
    s_mov_b64 exec, -1
    s_call_b64 s[80:81], L_hkv
    s_waitcnt vmcnt(8)
    s_barrier
    buffer_load_dword v9, v18, s[16:19], s90 offen offset:1664
    s_add_u32 m0, s87, 54080
    s_mov_b32 s46, 384
    buffer_load_dwordx4 v10, s[64:67], s46 offen lds
    buffer_load_dwordx4 v11, s[64:67], s46 offen offset:1040 lds
    s_add_u32 m0, s87, 62400
    s_nop 0
    buffer_load_dwordx4 v10, s[68:71], s46 offen lds
    buffer_load_dwordx4 v11, s[68:71], s46 offen offset:1040 lds
    s_mov_b32 m0, 53040
    s_mov_b64 exec, s[82:83]
    buffer_load_dwordx4 v12, s[64:67], s46 offen lds
    s_mov_b64 exec, -1
    s_call_b64 s[80:81], L_hkv
    s_waitcnt vmcnt(10)
    s_barrier
    s_add_u32 m0, s87, 71760
    s_mov_b32 s46, 512
    buffer_load_dwordx4 v10, s[64:67], s46 offen lds
    buffer_load_dwordx4 v11, s[64:67], s46 offen offset:1040 lds
    s_add_u32 m0, s87, 80080
    s_nop 0
    buffer_load_dwordx4 v10, s[68:71], s46 offen lds
    buffer_load_dwordx4 v11, s[68:71], s46 offen offset:1040 lds
    s_mov_b32 m0, 70720
    s_mov_b64 exec, s[82:83]
    buffer_load_dwordx4 v12, s[64:67], s46 offen lds
    s_mov_b64 exec, -1
    s_call_b64 s[80:81], L_hkv
    s_waitcnt vmcnt(9)
    s_barrier
    s_add_u32 m0, s87, 89440
    s_mov_b32 s46, 640
    buffer_load_dwordx4 v10, s[64:67], s46 offen lds
    buffer_load_dwordx4 v11, s[64:67], s46 offen offset:1040 lds
    s_add_u32 m0, s87, 97760
    s_nop 0
    buffer_load_dwordx4 v10, s[68:71], s46 offen lds
    buffer_load_dwordx4 v11, s[68:71], s46 offen offset:1040 lds
    s_mov_b32 m0, 88400
    s_mov_b64 exec, s[82:83]
    buffer_load_dwordx4 v12, s[64:67], s46 offen lds
    s_mov_b64 exec, -1
    s_call_b64 s[80:81], L_hkv
    s_waitcnt vmcnt(9)
    s_barrier
    s_add_u32 m0, s87, 107120
    s_mov_b32 s46, 768
    buffer_load_dwordx4 v10, s[64:67], s46 offen lds
    buffer_load_dwordx4 v11, s[64:67], s46 offen offset:1040 lds
    s_add_u32 m0, s87, 115440
    s_nop 0
    buffer_load_dwordx4 v10, s[68:71], s46 offen lds
    buffer_load_dwordx4 v11, s[68:71], s46 offen offset:1040 lds
    s_mov_b32 m0, 106080
    s_mov_b64 exec, s[82:83]
    buffer_load_dwordx4 v12, s[64:67], s46 offen lds
    s_mov_b64 exec, -1
    s_call_b64 s[80:81], L_hkv
    s_waitcnt vmcnt(9)
    s_barrier
    s_call_b64 s[80:81], L_hkv
    s_waitcnt vmcnt(4)
    s_barrier
    s_call_b64 s[80:81], L_hkv
    s_cmp_eq_u32 s36, 0
    s_cselect_b32 s46, 0, 0x40000000
    s_lshl_b32 s47, s84, 7
    s_add_u32 s46, s46, s47
    v_add_u32 v8, s46, v13
    s_mov_b32 s46, 131072
    v_mov_b32 v52, s43
    v_mov_b32 v53, s43
    v_mov_b32 v54, s43
    v_mov_b32 v55, s43
    s_waitcnt vmcnt(0)
    s_barrier
    s_mov_b64 exec, 0xff
    buffer_store_dwordx4 v[52:55], v8, s[12:15], s46 offen sc1
    s_mov_b64 exec, -1
    v_and_b32 v1, 3, v0
    v_lshlrev_b32 v1, 4, v1
    v_lshrrev_b32 v2, 2, v0
    v_mul_u32_u24 v3, 896, v2
    v_add_u32 v3, v3, v1
    s_mul_i32 s45, s89, 14336
    buffer_load_dwordx4 v[64:67], v3, s[4:7], s45 offen offset:0
    buffer_load_dwordx4 v[120:123], v1, s[76:79], 0 offen offset:0
    buffer_load_dwordx4 v[68:71], v3, s[4:7], s45 offen offset:64
    buffer_load_dwordx4 v[124:127], v1, s[76:79], 0 offen offset:64
    buffer_load_dwordx4 v[72:75], v3, s[4:7], s45 offen offset:128
    buffer_load_dwordx4 v[128:131], v1, s[76:79], 0 offen offset:128
    buffer_load_dwordx4 v[76:79], v3, s[4:7], s45 offen offset:192
    buffer_load_dwordx4 v[132:135], v1, s[76:79], 0 offen offset:192
    buffer_load_dwordx4 v[80:83], v3, s[4:7], s45 offen offset:256
    buffer_load_dwordx4 v[136:139], v1, s[76:79], 0 offen offset:256
    buffer_load_dwordx4 v[84:87], v3, s[4:7], s45 offen offset:320
    buffer_load_dwordx4 v[140:143], v1, s[76:79], 0 offen offset:320
    buffer_load_dwordx4 v[88:91], v3, s[4:7], s45 offen offset:384
    buffer_load_dwordx4 v[144:147], v1, s[76:79], 0 offen offset:384
    buffer_load_dwordx4 v[92:95], v3, s[4:7], s45 offen offset:448
    buffer_load_dwordx4 v[148:151], v1, s[76:79], 0 offen offset:448
    buffer_load_dwordx4 v[96:99], v3, s[4:7], s45 offen offset:512
    buffer_load_dwordx4 v[152:155], v1, s[76:79], 0 offen offset:512
    buffer_load_dwordx4 v[100:103], v3, s[4:7], s45 offen offset:576
    buffer_load_dwordx4 v[156:159], v1, s[76:79], 0 offen offset:576
    buffer_load_dwordx4 v[104:107], v3, s[4:7], s45 offen offset:640
    buffer_load_dwordx4 v[160:163], v1, s[76:79], 0 offen offset:640
    buffer_load_dwordx4 v[108:111], v3, s[4:7], s45 offen offset:704
    buffer_load_dwordx4 v[164:167], v1, s[76:79], 0 offen offset:704
    buffer_load_dwordx4 v[112:115], v3, s[4:7], s45 offen offset:768
    buffer_load_dwordx4 v[168:171], v1, s[76:79], 0 offen offset:768
    buffer_load_dwordx4 v[116:119], v3, s[4:7], s45 offen offset:832
    buffer_load_dwordx4 v[172:175], v1, s[76:79], 0 offen offset:832
    v_mov_b32 v56, 0
    v_mov_b32 v57, 0
    v_mov_b32 v58, 0
    v_mov_b32 v59, 0
    s_waitcnt vmcnt(26)
    v_dot2_f32_bf16 v56, v64, v120, v56
    v_dot2_f32_bf16 v57, v65, v121, v57
    v_dot2_f32_bf16 v58, v66, v122, v58
    v_dot2_f32_bf16 v59, v67, v123, v59
    s_waitcnt vmcnt(24)
    v_dot2_f32_bf16 v56, v68, v124, v56
    v_dot2_f32_bf16 v57, v69, v125, v57
    v_dot2_f32_bf16 v58, v70, v126, v58
    v_dot2_f32_bf16 v59, v71, v127, v59
    s_waitcnt vmcnt(22)
    v_dot2_f32_bf16 v56, v72, v128, v56
    v_dot2_f32_bf16 v57, v73, v129, v57
    v_dot2_f32_bf16 v58, v74, v130, v58
    v_dot2_f32_bf16 v59, v75, v131, v59
    s_waitcnt vmcnt(20)
    v_dot2_f32_bf16 v56, v76, v132, v56
    v_dot2_f32_bf16 v57, v77, v133, v57
    v_dot2_f32_bf16 v58, v78, v134, v58
    v_dot2_f32_bf16 v59, v79, v135, v59
    s_waitcnt vmcnt(18)
    v_dot2_f32_bf16 v56, v80, v136, v56
    v_dot2_f32_bf16 v57, v81, v137, v57
    v_dot2_f32_bf16 v58, v82, v138, v58
    v_dot2_f32_bf16 v59, v83, v139, v59
    s_waitcnt vmcnt(16)
    v_dot2_f32_bf16 v56, v84, v140, v56
    v_dot2_f32_bf16 v57, v85, v141, v57
    v_dot2_f32_bf16 v58, v86, v142, v58
    v_dot2_f32_bf16 v59, v87, v143, v59
    s_waitcnt vmcnt(14)
    v_dot2_f32_bf16 v56, v88, v144, v56
    v_dot2_f32_bf16 v57, v89, v145, v57
    v_dot2_f32_bf16 v58, v90, v146, v58
    v_dot2_f32_bf16 v59, v91, v147, v59
    s_waitcnt vmcnt(12)
    v_dot2_f32_bf16 v56, v92, v148, v56
    v_dot2_f32_bf16 v57, v93, v149, v57
    v_dot2_f32_bf16 v58, v94, v150, v58
    v_dot2_f32_bf16 v59, v95, v151, v59
    s_waitcnt vmcnt(10)
    v_dot2_f32_bf16 v56, v96, v152, v56
    v_dot2_f32_bf16 v57, v97, v153, v57
    v_dot2_f32_bf16 v58, v98, v154, v58
    v_dot2_f32_bf16 v59, v99, v155, v59
    s_waitcnt vmcnt(8)
    v_dot2_f32_bf16 v56, v100, v156, v56
    v_dot2_f32_bf16 v57, v101, v157, v57
    v_dot2_f32_bf16 v58, v102, v158, v58
    v_dot2_f32_bf16 v59, v103, v159, v59
    s_waitcnt vmcnt(6)
    v_dot2_f32_bf16 v56, v104, v160, v56
    v_dot2_f32_bf16 v57, v105, v161, v57
    v_dot2_f32_bf16 v58, v106, v162, v58
    v_dot2_f32_bf16 v59, v107, v163, v59
    s_waitcnt vmcnt(4)
    v_dot2_f32_bf16 v56, v108, v164, v56
    v_dot2_f32_bf16 v57, v109, v165, v57
    v_dot2_f32_bf16 v58, v110, v166, v58
    v_dot2_f32_bf16 v59, v111, v167, v59
    s_waitcnt vmcnt(2)
    v_dot2_f32_bf16 v56, v112, v168, v56
    v_dot2_f32_bf16 v57, v113, v169, v57
    v_dot2_f32_bf16 v58, v114, v170, v58
    v_dot2_f32_bf16 v59, v115, v171, v59
    s_waitcnt vmcnt(0)
    v_dot2_f32_bf16 v56, v116, v172, v56
    v_dot2_f32_bf16 v57, v117, v173, v57
    v_dot2_f32_bf16 v58, v118, v174, v58
    v_dot2_f32_bf16 v59, v119, v175, v59
    s_nop 3
    v_add_f32 v56, v56, v57
    v_add_f32 v58, v58, v59
    v_add_f32 v56, v56, v58
    s_nop 1
    v_add_f32_dpp v56, v56, v56 quad_perm:[1,0,3,2] row_mask:0xf bank_mask:0xf
    s_nop 1
    v_add_f32_dpp v56, v56, v56 quad_perm:[2,3,0,1] row_mask:0xf bank_mask:0xf
    v_mul_f32 v56, 0xbfb8aa3b, v56
    v_exp_f32 v56, v56
    s_nop 0
    v_add_f32 v56, 1.0, v56
    v_rcp_f32 v52, v56
    v_lshlrev_b32 v2, 3, v2
    s_lshl_b32 s45, s89, 7
    s_add_u32 s45, s45, 32768
    s_mov_b32 exec_lo, 0x11111111
    s_mov_b32 exec_hi, 0x11111111
    buffer_store_dwordx2 v[52:53], v2, s[12:15], s45 offen sc1
    s_mov_b64 exec, -1
L_hend:
    s_endpgm
L_hkv:
    ds_read_b128 v[56:59], v15
    ds_read2_b32 v[64:65], v19 offset0:128 offset1:160
    ds_read2_b32 v[66:67], v19 offset0:192 offset1:224
    ds_read2_b32 v[68:69], v20 offset0:0 offset1:32
    ds_read2_b32 v[70:71], v20 offset0:64 offset1:96
    ds_read2_b32 v[72:73], v20 offset0:128 offset1:160
    ds_read2_b32 v[74:75], v20 offset0:192 offset1:224
    ds_read2_b32 v[76:77], v21 offset0:0 offset1:32
    ds_read2_b32 v[78:79], v21 offset0:64 offset1:96
    ds_read2_b32 v[80:81], v21 offset0:128 offset1:160
    ds_read2_b32 v[82:83], v21 offset0:192 offset1:224
    v_add_u32 v19, 17680, v19
    v_add_u32 v20, 17680, v20
    v_add_u32 v21, 17680, v21
    v_add_u32 v15, 512, v15
    s_waitcnt lgkmcnt(4)
    v_lshlrev_b32 v84, 16, v56
    v_lshlrev_b32 v85, 16, v58
    v_and_b32 v86, 0xffff0000, v56
    v_and_b32 v87, 0xffff0000, v58
    v_lshlrev_b32 v88, 16, v57
    v_lshlrev_b32 v89, 16, v59
    v_and_b32 v90, 0xffff0000, v57
    v_and_b32 v91, 0xffff0000, v59
    v_lshlrev_b32 v94, 16, v65
    v_and_b32 v95, 0xffff0000, v65
    v_lshlrev_b32 v96, 16, v66
    v_and_b32 v97, 0xffff0000, v66
    v_lshlrev_b32 v98, 16, v67
    v_and_b32 v99, 0xffff0000, v67
    v_lshlrev_b32 v100, 16, v68
    v_and_b32 v101, 0xffff0000, v68
    v_lshlrev_b32 v102, 16, v69
    v_and_b32 v103, 0xffff0000, v69
    v_lshlrev_b32 v104, 16, v70
    v_and_b32 v105, 0xffff0000, v70
    v_lshlrev_b32 v106, 16, v71
    v_and_b32 v107, 0xffff0000, v71
    v_lshlrev_b32 v108, 16, v72
    v_and_b32 v109, 0xffff0000, v72
    v_lshlrev_b32 v110, 16, v73
    v_and_b32 v111, 0xffff0000, v73
    v_lshlrev_b32 v112, 16, v74
    v_and_b32 v113, 0xffff0000, v74
    v_lshlrev_b32 v114, 16, v75
    v_and_b32 v115, 0xffff0000, v75
    v_pk_mul_f32 v[116:117], v[90:91], v[94:95]
    v_pk_mul_f32 v[118:119], v[90:91], v[96:97]
    v_pk_mul_f32 v[120:121], v[90:91], v[98:99]
    v_pk_mul_f32 v[122:123], v[90:91], v[100:101]
    v_pk_mul_f32 v[124:125], v[90:91], v[102:103]
    v_pk_mul_f32 v[126:127], v[90:91], v[104:105]
    v_pk_mul_f32 v[128:129], v[90:91], v[106:107]
    v_pk_mul_f32 v[130:131], v[90:91], v[108:109]
    v_pk_fma_f32 v[116:117], v[88:89], v[96:97], v[116:117]
    v_pk_fma_f32 v[118:119], v[88:89], v[98:99], v[118:119]
    v_pk_fma_f32 v[120:121], v[88:89], v[100:101], v[120:121]
    v_pk_fma_f32 v[122:123], v[88:89], v[102:103], v[122:123]
    v_pk_fma_f32 v[124:125], v[88:89], v[104:105], v[124:125]
    v_pk_fma_f32 v[126:127], v[88:89], v[106:107], v[126:127]
    v_pk_fma_f32 v[128:129], v[88:89], v[108:109], v[128:129]
    v_pk_fma_f32 v[130:131], v[88:89], v[110:111], v[130:131]
    v_pk_fma_f32 v[116:117], v[86:87], v[98:99], v[116:117]
    v_pk_fma_f32 v[118:119], v[86:87], v[100:101], v[118:119]
    v_pk_fma_f32 v[120:121], v[86:87], v[102:103], v[120:121]
    v_pk_fma_f32 v[122:123], v[86:87], v[104:105], v[122:123]
    v_pk_fma_f32 v[124:125], v[86:87], v[106:107], v[124:125]
    v_pk_fma_f32 v[126:127], v[86:87], v[108:109], v[126:127]
    v_pk_fma_f32 v[128:129], v[86:87], v[110:111], v[128:129]
    v_pk_fma_f32 v[130:131], v[86:87], v[112:113], v[130:131]
    v_pk_fma_f32 v[116:117], v[84:85], v[100:101], v[116:117]
    v_pk_fma_f32 v[118:119], v[84:85], v[102:103], v[118:119]
    v_pk_fma_f32 v[120:121], v[84:85], v[104:105], v[120:121]
    v_pk_fma_f32 v[122:123], v[84:85], v[106:107], v[122:123]
    v_pk_fma_f32 v[124:125], v[84:85], v[108:109], v[124:125]
    v_pk_fma_f32 v[126:127], v[84:85], v[110:111], v[126:127]
    v_pk_fma_f32 v[128:129], v[84:85], v[112:113], v[128:129]
    v_pk_fma_f32 v[130:131], v[84:85], v[114:115], v[130:131]
    s_waitcnt lgkmcnt(0)
    v_lshlrev_b32 v92, 16, v76
    v_and_b32 v93, 0xffff0000, v76
    v_lshlrev_b32 v94, 16, v77
    v_and_b32 v95, 0xffff0000, v77
    v_lshlrev_b32 v96, 16, v78
    v_and_b32 v97, 0xffff0000, v78
    v_lshlrev_b32 v98, 16, v79
    v_and_b32 v99, 0xffff0000, v79
    v_lshlrev_b32 v100, 16, v80
    v_and_b32 v101, 0xffff0000, v80
    v_lshlrev_b32 v102, 16, v81
    v_and_b32 v103, 0xffff0000, v81
    v_lshlrev_b32 v104, 16, v82
    v_and_b32 v105, 0xffff0000, v82
    v_lshlrev_b32 v106, 16, v83
    v_and_b32 v107, 0xffff0000, v83
    v_pk_mul_f32 v[116:117], v[116:117], v[92:93]
    v_pk_mul_f32 v[118:119], v[118:119], v[94:95]
    v_pk_mul_f32 v[120:121], v[120:121], v[96:97]
    v_pk_mul_f32 v[122:123], v[122:123], v[98:99]
    v_pk_mul_f32 v[124:125], v[124:125], v[100:101]
    v_pk_mul_f32 v[126:127], v[126:127], v[102:103]
    v_pk_mul_f32 v[128:129], v[128:129], v[104:105]
    v_pk_mul_f32 v[130:131], v[130:131], v[106:107]
    v_cvt_pk_bf16_f32 v132, v130, v128
    v_cvt_pk_bf16_f32 v133, v126, v124
    v_cvt_pk_bf16_f32 v134, v122, v120
    v_cvt_pk_bf16_f32 v135, v118, v116
    v_cvt_pk_bf16_f32 v136, v131, v129
    v_cvt_pk_bf16_f32 v137, v127, v125
    v_cvt_pk_bf16_f32 v138, v123, v121
    v_cvt_pk_bf16_f32 v139, v119, v117
    s_add_u32 s45, s88, 4096
    buffer_store_dwordx4 v[132:135], v14, s[12:15], s88 offen sc1
    buffer_store_dwordx4 v[136:139], v14, s[12:15], s45 offen sc1
    s_add_u32 s88, s88, 262144
    s_setpc_b64 s[80:81]
L_pad:
.if (L_pad - L_body) < 39936
.fill (39936 - (L_pad - L_body)) / 4, 4, 0xbf800000
.endif
    s_endpgm
.section .rodata,"a"
.p2align 6
.amdhsa_kernel gated_mix__ssm_conv_h3__mixer_gmlp__prompt_kernel
  .amdhsa_next_free_vgpr 512
  .amdhsa_next_free_sgpr 102
  .amdhsa_accum_offset 256
  .amdhsa_group_segment_fixed_size 0
  .amdhsa_kernarg_size 120
  .amdhsa_user_sgpr_count 2
  .amdhsa_user_sgpr_kernarg_segment_ptr 1
  .amdhsa_system_sgpr_workgroup_id_x 1
  .amdhsa_float_denorm_mode_32 3
.end_amdhsa_kernel
```
